```python
import torch

def _softmax(x, axis=-1):
    return torch.softmax(x, dim=axis)

def _gelu(x):
    return torch.nn.functional.gelu(x, approximate='tanh')

def _silu(x):
    return torch.nn.functional.silu(x)

def _sigmoid(x):
    return torch.sigmoid(x)

def _layernorm(x, axis=-1, eps=1e-05):
    m = x.mean(dim=axis, keepdim=True)
    v = x.var(dim=axis, keepdim=True, unbiased=False)
    return (x - m) / torch.sqrt(v + eps)

def _scatter_add(tgt, idx, src, axis=0):
    return tgt.clone().index_add_(axis, idx, src)

def _segment_sum(src, seg, n):
    out = torch.zeros((n,) + src.shape[1:], dtype=src.dtype)
    return out.index_add_(0, seg, src)

def _pad(x, pw):
    flat = tuple((v for pair in reversed(pw) for v in pair))
    return torch.nn.functional.pad(x, flat)
kernel_name = 'adaLN_cond__sliding_block_cached__glu_gated_reglu__decode'

def setup_inputs():

    _w = lambda a: (lambda t: t.to(torch.bfloat16) if t.is_floating_point() else t)(torch.as_tensor(a))

    def _A_setup():
        B, Sq, D = (8, 1, 640)
        Hq, Hkv, Sk, Dh = (32, 32, 4096, 128)
        assert Hq % Hkv == 0, (Hq, Hkv)
        return {'x': _w((lambda *s: torch.randn(*s, dtype=torch.bfloat16) * 0.05)(B, Sq, D)), 'k_cache': _w((lambda *s: torch.randn(*s, dtype=torch.bfloat16) * 3.2)(B, Hkv, Sk, Dh)), 'v_cache': _w((lambda *s: torch.randn(*s, dtype=torch.bfloat16) * 3.2)(B, Hkv, Sk, Dh)), 'wq': _w((lambda *s: torch.randn(*s, dtype=torch.bfloat16) * 3.2)(D, Hq * Dh) * D ** (-0.5)), 'wo': _w((lambda *s: torch.randn(*s, dtype=torch.bfloat16) * 3.2)(Hq * Dh, D) * (Hq * Dh) ** (-0.5))}
    _A_in = _A_setup()

    def _B_setup():
        B, S, D, F = (8, 1, 640, 1728)
        return {'x': _w((lambda *s: torch.randn(*s, dtype=torch.bfloat16) * 0.05)(B, S, D)), 'W_gate': _w((lambda *s: torch.randn(*s, dtype=torch.bfloat16) * 1.6)(D, F) * (2.0 / D) ** 0.5), 'W_up': _w((lambda *s: torch.randn(*s, dtype=torch.bfloat16) * 1.6)(D, F) * (2.0 / D) ** 0.5), 'W_down': _w((lambda *s: torch.randn(*s, dtype=torch.bfloat16) * 1.6)(F, D) * (1.0 / F) ** 0.5)}
    _B_in = _B_setup()
    return {'A_x': _A_in['x'], 'A_k_cache': _A_in['k_cache'], 'A_v_cache': _A_in['v_cache'], 'A_wq': _A_in['wq'], 'A_wo': _A_in['wo'], 'B_x': _B_in['x'], 'B_W_gate': _B_in['W_gate'], 'B_W_up': _B_in['W_up'], 'B_W_down': _B_in['W_down'], 'c': _w((lambda *s: torch.randn(*s, dtype=torch.bfloat16) * 0.2)(8, 640) * 8.0), 'w_mod': _w((lambda *s: torch.randn(*s, dtype=torch.bfloat16) * 0.2)(640, 6 * 640) * 640 ** (-0.5) * 8.0)}

def reference(A_x, A_k_cache, A_v_cache, A_wq, A_wo, B_x, B_W_gate, B_W_up, B_W_down, c, w_mod):

    def _A_ref(x, k_cache, v_cache, wq, wo):
        B, Sq, D = x.shape
        Hq, Dh = (32, 128)
        Hkv, Sk = (k_cache.shape[1], k_cache.shape[2])
        W = min(4096, max(256, Sk // 4))
        rep = Hq // Hkv
        q = (lambda x, *d: x.permute(*d))((x @ wq).reshape(B, Sq, Hq, Dh), 0, 2, 1, 3)
        k = (lambda x, n, axis: torch.repeat_interleave(x, n, dim=axis))(k_cache[:, :, Sk - W:, :], rep, axis=1)
        v = (lambda x, n, axis: torch.repeat_interleave(x, n, dim=axis))(v_cache[:, :, Sk - W:, :], rep, axis=1)
        scores = torch.einsum('bhqd,bhkd->bhqk', q, k) * Dh ** (-0.5)
        p = _softmax(scores, axis=-1)
        o = torch.einsum('bhqk,bhkd->bhqd', p, v)
        return (lambda x, *d: x.permute(*d))(o, 0, 2, 1, 3).reshape(B, Sq, Hq * Dh) @ wo

    def _B_ref(x, W_gate, W_up, W_down):
        gate = torch.einsum('bsd,df->bsf', x, W_gate)
        up = torch.einsum('bsd,df->bsf', x, W_up)
        gate = gate * (lambda x, dt: x.to(dt))(gate > 0, gate.dtype)
        h = gate * up
        return torch.einsum('bsf,fd->bsd', h, W_down)
    x = A_x
    mod = (_silu(c) @ w_mod).reshape(c.shape[0], 6, 1, -1)
    sa, ca, ga, sb, cb, gb = (mod[:, 0].clone(), mod[:, 1].clone(), mod[:, 2].clone(), mod[:, 3].clone(), mod[:, 4].clone(), mod[:, 5].clone())
    h = _layernorm(x, axis=-1) * (1 + ca) + sa
    x = x + ga * _A_ref(h, A_k_cache, A_v_cache, A_wq, A_wo)
    h = _layernorm(x, axis=-1) * (1 + cb) + sb
    x = x + gb * _B_ref(h, B_W_gate, B_W_up, B_W_down)
    return x
```

```asm
; @launch grid=(256,1,1) block=(768,1,1) lds=163840
.amdgcn_target "amdgcn-amd-amdhsa--gfx950"
.text
.globl adaLN_cond__sliding_block_cached__glu_gated_reglu__decode_kernel
.p2align 8
.type adaLN_cond__sliding_block_cached__glu_gated_reglu__decode_kernel,@function
adaLN_cond__sliding_block_cached__glu_gated_reglu__decode_kernel:
    s_load_dwordx16 s[16:31], s[0:1], 0
    v_lshrrev_b32 v1, 6, v0
    s_getpc_b64 s[86:87]
L_pc0:
    v_readfirstlane_b32 s3, v1
    v_lshlrev_b32 v3, 7, v0
    s_cmpk_ge_u32 s2, 256
    s_cbranch_scc1 L_end
    v_min_u32 v3, L_code_end-L_pc0-4, v3
    v_and_b32 v2, 63, v0
    global_load_dword v161, v3, s[86:87]
    s_load_dwordx8 s[32:39], s[0:1], 64
    s_load_dwordx4 s[40:43], s[0:1], 96
    v_lshlrev_b32 v7, 4, v2
    s_cmp_lt_u32 s3, 4
    s_cbranch_scc1 L_control
    s_sub_u32 s15, s3, 4
    s_lshl_b32 s85, s15, 15
    v_add_u32 v1, s85, v7
    s_mul_i32 s91, s2, 3
    s_add_u32 s91, s91, s15
    s_and_b32 s91, s91, 31
    s_lshl_b32 s91, s91, 10
    s_lshl_b32 s85, s2, 2
    s_add_u32 s85, s85, 3
    s_lshl_b32 s85, s85, 18
    s_mov_b32 s51, 0x20000
    s_lshl_b32 s50, s51, 1
    s_movk_i32 s90, 0x7fff
    s_addk_i32 s91, 1024
    s_and_b32 s92, s91, s90
    s_addk_i32 s91, -1024
    s_waitcnt lgkmcnt(0)
    s_add_u32 s48, s18, s85
    s_addc_u32 s49, s19, 0
    buffer_load_dwordx4 v[40:43], v1, s[48:51], s91 offen nt
    buffer_load_dwordx4 v[44:47], v1, s[48:51], s92 offen nt
    s_add_u32 s52, s20, s85
    s_addc_u32 s53, s21, 0
    s_mov_b32 s54, 0x40000
    s_mov_b32 s55, 0x20000
    s_barrier
    v_mov_b32 v13, 81920
    s_mov_b32 s84, 0xffff0000
    v_mov_b32 v15, 0
    s_lshr_b32 s13, s2, 5
    s_and_b32 s14, s2, 31
    s_mov_b32 s44, s42
    s_mov_b32 s45, s43
    s_mov_b32 s46, 2097152
    s_mov_b32 s47, 0x20000
    s_and_b32 s4, s2, 7
    s_lshr_b32 s5, s2, 3
    s_mov_b32 s7, 0
    s_mov_b32 s8, 0
    s_sub_u32 s9, s5, 0
    s_mul_i32 s10, s4, 2
    s_add_u32 s10, s10, s9
    s_cmp_lt_u32 s9, 2
    s_cselect_b32 s7, 1, s7
    s_cselect_b32 s8, s10, s8
    s_sub_u32 s9, s5, 6
    s_mul_i32 s10, s4, 8
    s_add_u32 s10, s10, s9
    s_cmp_lt_u32 s9, 8
    s_cselect_b32 s7, 4, s7
    s_cselect_b32 s8, s10, s8
    s_sub_u32 s9, s5, 14
    s_mul_i32 s10, s4, 5
    s_add_u32 s10, s10, s9
    s_cmp_lt_u32 s9, 5
    s_cselect_b32 s7, 5, s7
    s_cselect_b32 s8, s10, s8
    s_sub_u32 s9, s5, 19
    s_mul_i32 s10, s4, 6
    s_add_u32 s10, s10, s9
    s_cmp_lt_u32 s9, 6
    s_cselect_b32 s7, 3, s7
    s_cselect_b32 s8, s10, s8
    s_sub_u32 s9, s5, 25
    s_mul_i32 s10, s4, 4
    s_add_u32 s10, s10, s9
    s_cmp_lt_u32 s9, 4
    s_cselect_b32 s7, 2, s7
    s_cselect_b32 s8, s10, s8
    s_sub_u32 s9, s5, 29
    s_mul_i32 s10, s4, 1
    s_add_u32 s10, s10, s9
    s_cmp_lt_u32 s9, 1
    s_cselect_b32 s7, 6, s7
    s_cselect_b32 s8, s10, s8
    s_sub_u32 s9, s5, 2
    s_lshr_b32 s10, s9, 1
    s_and_b32 s10, s10, 1
    s_lshl_b32 s11, s4, 1
    s_add_u32 s10, s10, s11
    s_lshl_b32 s10, s10, 2
    s_mov_b32 s86, 15336802
    s_mov_b32 s87, 11599987
    s_lshr_b64 s[86:87], s[86:87], s10
    s_and_b32 s10, s86, 3
    s_bfe_u32 s11, s86, 0x20002
    s_lshl_b32 s11, s11, 1
    s_lshl_b32 s12, s10, 4
    s_add_u32 s11, s11, s12
    s_and_b32 s12, s9, 1
    s_add_u32 s11, s11, s12
    s_cmp_lt_u32 s9, 4
    s_cselect_b32 s7, s10, s7
    s_cselect_b32 s8, s11, s8
    s_sub_u32 s9, s5, 19
    s_cmp_lt_u32 s9, 10
    s_cselect_b32 s6, s9, 99
    s_sub_u32 s10, s5, 20
    s_cmp_ge_u32 s5, 30
    s_cselect_b32 s6, s10, s6
    s_sub_u32 s9, s5, 2
    s_add_u32 s10, s9, 12
    s_cmp_lt_u32 s9, 4
    s_cselect_b32 s6, s10, s6
    s_cmp_lg_u32 s7, 1
    s_cbranch_scc1 L_nohold
    s_mov_b32 s56, s34
    s_mov_b32 s57, s35
    s_mov_b32 s58, 10240
    s_mov_b32 s59, 0x20000
    s_mov_b32 s60, s16
    s_mov_b32 s61, s17
    s_mov_b32 s62, 10240
    s_mov_b32 s63, 0x20000
    s_mul_i32 s90, s15, 1280
    v_lshlrev_b32 v12, 2, v2
    buffer_load_dword v80, v12, s[56:59], s90 offen offset:0
    buffer_load_dword v81, v12, s[56:59], s90 offen offset:256
    buffer_load_dword v82, v12, s[56:59], s90 offen offset:512
    buffer_load_dword v83, v12, s[56:59], s90 offen offset:768
    buffer_load_dword v84, v12, s[56:59], s90 offen offset:1024
    buffer_load_dword v86, v12, s[60:63], s90 offen offset:0
    buffer_load_dword v87, v12, s[60:63], s90 offen offset:256
    buffer_load_dword v88, v12, s[60:63], s90 offen offset:512
    buffer_load_dword v89, v12, s[60:63], s90 offen offset:768
    buffer_load_dword v90, v12, s[60:63], s90 offen offset:1024
    s_mov_b64 exec, 1
    v_mov_b32 v14, 1
    ds_add_u32 v13, v14 offset:52
    s_mov_b64 exec, -1
    s_mul_i32 s90, s15, 1344
    s_add_u32 s90, s90, 143360
    v_add_u32 v12, s90, v12
    s_mov_b32 s85, 3216550459
    s_waitcnt vmcnt(5)
    v_lshlrev_b32 v100, 16, v80
    v_and_b32 v101, s84, v80
    v_lshlrev_b32 v102, 16, v81
    v_and_b32 v103, s84, v81
    v_lshlrev_b32 v104, 16, v82
    v_and_b32 v105, s84, v82
    v_lshlrev_b32 v106, 16, v83
    v_and_b32 v107, s84, v83
    v_lshlrev_b32 v108, 16, v84
    v_and_b32 v109, s84, v84
    v_mul_f32 v112, s85, v100
    v_mul_f32 v113, s85, v101
    v_mul_f32 v114, s85, v102
    v_mul_f32 v115, s85, v103
    v_mul_f32 v116, s85, v104
    v_mul_f32 v117, s85, v105
    v_mul_f32 v118, s85, v106
    v_mul_f32 v119, s85, v107
    v_mul_f32 v120, s85, v108
    v_mul_f32 v121, s85, v109
    v_exp_f32 v112, v112
    v_exp_f32 v113, v113
    v_exp_f32 v114, v114
    v_exp_f32 v115, v115
    v_exp_f32 v116, v116
    v_exp_f32 v117, v117
    v_exp_f32 v118, v118
    v_exp_f32 v119, v119
    v_exp_f32 v120, v120
    v_exp_f32 v121, v121
    v_add_f32 v112, 1.0, v112
    v_add_f32 v113, 1.0, v113
    v_add_f32 v114, 1.0, v114
    v_add_f32 v115, 1.0, v115
    v_add_f32 v116, 1.0, v116
    v_add_f32 v117, 1.0, v117
    v_add_f32 v118, 1.0, v118
    v_add_f32 v119, 1.0, v119
    v_add_f32 v120, 1.0, v120
    v_add_f32 v121, 1.0, v121
    v_rcp_f32 v112, v112
    v_rcp_f32 v113, v113
    v_rcp_f32 v114, v114
    v_rcp_f32 v115, v115
    v_rcp_f32 v116, v116
    v_rcp_f32 v117, v117
    v_rcp_f32 v118, v118
    v_rcp_f32 v119, v119
    v_rcp_f32 v120, v120
    v_rcp_f32 v121, v121
    v_mul_f32 v100, v100, v112
    v_mul_f32 v101, v101, v113
    v_mul_f32 v102, v102, v114
    v_mul_f32 v103, v103, v115
    v_mul_f32 v104, v104, v116
    v_mul_f32 v105, v105, v117
    v_mul_f32 v106, v106, v118
    v_mul_f32 v107, v107, v119
    v_mul_f32 v108, v108, v120
    v_mul_f32 v109, v109, v121
    v_cvt_pk_bf16_f32 v80, v100, v101
    v_cvt_pk_bf16_f32 v81, v102, v103
    v_cvt_pk_bf16_f32 v82, v104, v105
    v_cvt_pk_bf16_f32 v83, v106, v107
    v_cvt_pk_bf16_f32 v84, v108, v109
    ds_write_b32 v12, v80 offset:0
    ds_write_b32 v12, v81 offset:256
    ds_write_b32 v12, v82 offset:512
    ds_write_b32 v12, v83 offset:768
    ds_write_b32 v12, v84 offset:1024
    s_waitcnt vmcnt(0)
    v_lshlrev_b32 v100, 16, v86
    v_and_b32 v101, s84, v86
    v_lshlrev_b32 v102, 16, v87
    v_and_b32 v103, s84, v87
    v_lshlrev_b32 v104, 16, v88
    v_and_b32 v105, s84, v88
    v_lshlrev_b32 v106, 16, v89
    v_and_b32 v107, s84, v89
    v_lshlrev_b32 v108, 16, v90
    v_and_b32 v109, s84, v90
    v_pk_add_f32 v[112:113], v[100:101], v[102:103]
    v_pk_add_f32 v[114:115], v[104:105], v[106:107]
    v_pk_add_f32 v[112:113], v[112:113], v[108:109]
    v_pk_add_f32 v[112:113], v[112:113], v[114:115]
    v_add_f32 v112, v112, v113
    s_nop 1
    v_add_f32_dpp v112, v112, v112 row_ror:8 row_mask:0xf bank_mask:0xf
    s_nop 1
    v_add_f32_dpp v112, v112, v112 row_ror:4 row_mask:0xf bank_mask:0xf
    s_nop 1
    v_add_f32_dpp v112, v112, v112 row_ror:2 row_mask:0xf bank_mask:0xf
    s_nop 1
    v_add_f32_dpp v112, v112, v112 row_ror:1 row_mask:0xf bank_mask:0xf
    s_nop 1
    v_add_f32_dpp v112, v112, v112 row_bcast:15 row_mask:0xa bank_mask:0xf
    s_nop 1
    v_add_f32_dpp v112, v112, v112 row_bcast:31 row_mask:0xc bank_mask:0xf
    v_mul_f32 v112, 0x3acccccd, v112
    s_nop 0
    v_readlane_b32 s86, v112, 63
    v_cvt_pk_bf16_f32 v112, 0, v112
    s_nop 0
    v_readlane_b32 s90, v112, 63
    v_pk_add_f32 v[114:115], v[100:101], s[86:87] op_sel_hi:[1,0] neg_lo:[0,1] neg_hi:[0,1]
    v_pk_mul_f32 v[112:113], v[114:115], v[114:115]
    v_pk_add_f32 v[114:115], v[102:103], s[86:87] op_sel_hi:[1,0] neg_lo:[0,1] neg_hi:[0,1]
    v_pk_fma_f32 v[112:113], v[114:115], v[114:115], v[112:113]
    v_pk_add_f32 v[114:115], v[104:105], s[86:87] op_sel_hi:[1,0] neg_lo:[0,1] neg_hi:[0,1]
    v_pk_fma_f32 v[112:113], v[114:115], v[114:115], v[112:113]
    v_pk_add_f32 v[114:115], v[106:107], s[86:87] op_sel_hi:[1,0] neg_lo:[0,1] neg_hi:[0,1]
    v_pk_fma_f32 v[112:113], v[114:115], v[114:115], v[112:113]
    v_pk_add_f32 v[114:115], v[108:109], s[86:87] op_sel_hi:[1,0] neg_lo:[0,1] neg_hi:[0,1]
    v_pk_fma_f32 v[112:113], v[114:115], v[114:115], v[112:113]
    v_add_f32 v112, v112, v113
    s_nop 1
    v_add_f32_dpp v112, v112, v112 row_ror:8 row_mask:0xf bank_mask:0xf
    s_nop 1
    v_add_f32_dpp v112, v112, v112 row_ror:4 row_mask:0xf bank_mask:0xf
    s_nop 1
    v_add_f32_dpp v112, v112, v112 row_ror:2 row_mask:0xf bank_mask:0xf
    s_nop 1
    v_add_f32_dpp v112, v112, v112 row_ror:1 row_mask:0xf bank_mask:0xf
    s_nop 1
    v_add_f32_dpp v112, v112, v112 row_bcast:15 row_mask:0xa bank_mask:0xf
    s_nop 1
    v_add_f32_dpp v112, v112, v112 row_bcast:31 row_mask:0xc bank_mask:0xf
    v_mul_f32 v112, 0x3acccccd, v112
    v_cvt_pk_bf16_f32 v112, 0, v112
    v_add_f32 v112, 0x3727c5ac, v112
    v_cvt_pk_bf16_f32 v112, 0, v112
    v_sqrt_f32 v112, v112
    s_nop 0
    v_cvt_pk_bf16_f32 v112, 0, v112
    v_rcp_f32 v112, v112
    s_nop 0
    v_readlane_b32 s92, v112, 63
    v_mov_b32 v28, s90
    s_nop 0
    v_mov_b32 v29, s92
    s_lshl_b32 s85, s15, 3
    v_add_u32 v30, s85, v13
    ds_write_b64 v30, v[28:29] offset:64
    s_mov_b64 exec, 1
    v_mov_b32 v14, 1
    ds_add_u32 v13, v14 offset:40
    s_mov_b64 exec, -1
L_hold:
    s_mov_b32 s89, 1048576
L_lw_1:
    ds_read_b32 v14, v13 offset:28
    s_waitcnt lgkmcnt(0)
    v_readfirstlane_b32 s88, v14
    s_nop 0
    s_cmp_ge_u32 s88, 4
    s_cbranch_scc1 L_lwd_2
    s_sleep 2
    s_sub_u32 s89, s89, 1
    s_cbranch_scc0 L_lw_1
L_lwd_2:
L_nohold:
    s_add_u32 s92, s91, 2048
    s_and_b32 s92, s92, 32767
    buffer_load_dwordx4 v[48:51], v1, s[48:51], s92 offen nt
    v_mov_b32 v3, 0
    buffer_load_dword v35, v3, s[44:47], 0 offen sc1
    v_and_b32 v3, 15, v2
    v_lshlrev_b32 v12, 5, v3
    s_lshl_b32 s93, s2, 9
    s_add_u32 s93, s93, 32768
    v_mov_b32 v16, 0xffff
    v_mov_b32 v17, s84
    v_cmp_eq_u32 vcc, 0, v3
    s_nop 1
    v_cndmask_b32 v8, 0, v16, vcc
    v_cmp_eq_u32 vcc, 1, v3
    s_nop 1
    v_cndmask_b32 v8, v8, v17, vcc
    v_cmp_eq_u32 vcc, 2, v3
    s_nop 1
    v_cndmask_b32 v9, 0, v16, vcc
    v_cmp_eq_u32 vcc, 3, v3
    s_nop 1
    v_cndmask_b32 v9, v9, v17, vcc
    v_cmp_eq_u32 vcc, 4, v3
    s_nop 1
    v_cndmask_b32 v10, 0, v16, vcc
    v_cmp_eq_u32 vcc, 5, v3
    s_nop 1
    v_cndmask_b32 v10, v10, v17, vcc
    v_cmp_eq_u32 vcc, 6, v3
    s_nop 1
    v_cndmask_b32 v11, 0, v16, vcc
    v_cmp_eq_u32 vcc, 7, v3
    s_nop 1
    v_cndmask_b32 v11, v11, v17, vcc
    s_mov_b32 s96, 0xcccccccc
    s_mov_b32 s97, 0xcccccccc
    s_mov_b32 s98, 0xaaaaaaaa
    s_mov_b32 s99, 0xaaaaaaaa
    s_mul_i32 s85, s14, 163840
    s_add_u32 s56, s24, s85
    s_addc_u32 s57, s25, 0
    s_mov_b32 s58, 163840
    s_mov_b32 s59, 0x20000
    v_lshrrev_b32 v34, 4, v2
    v_mul_u32_u24 v34, 5120, v34
    v_lshl_add_u32 v34, v3, 4, v34
    s_mul_i32 s85, s15, 20480
    v_add_u32 v34, s85, v34
    s_lshr_b32 s85, 2, s7
    s_bitcmp1_b32 s85, 0
    s_cselect_b64 vcc, -1, 0
    s_waitcnt vmcnt(2)
    s_add_u32 s92, s91, 3072
    s_and_b32 s92, s92, 32767
    buffer_load_dwordx4 v[52:55], v1, s[48:51], s92 offen nt
    s_waitcnt vmcnt(2)
    s_add_u32 s92, s91, 4096
    s_and_b32 s92, s92, 32767
    buffer_load_dwordx4 v[56:59], v1, s[48:51], s92 offen nt
    s_lshl_b32 s85, s15, 10
    s_add_u32 m0, s85, 90112
    s_movk_i32 s85, 0
    buffer_load_dwordx4 v34, s[56:59], s85 offen  lds
    s_waitcnt vmcnt(2)
    s_mov_b64 exec, 1
    v_mov_b32 v14, 1
    ds_add_u32 v13, v14 offset:44
    s_mov_b64 exec, -1
    s_add_u32 s92, s91, 5120
    s_and_b32 s92, s92, 32767
    buffer_load_dwordx4 v[60:63], v1, s[48:51], s92 offen nt
    s_waitcnt vmcnt(3)
    s_cbranch_vccnz L_kw_3
    s_waitcnt vmcnt(2)
L_kw_3:
    s_add_u32 s92, s91, 6144
    s_and_b32 s92, s92, 32767
    buffer_load_dwordx4 v[64:67], v1, s[48:51], s92 offen nt
    s_waitcnt vmcnt(3)
    s_cbranch_vccnz L_kw_4
    s_waitcnt vmcnt(2)
L_kw_4:
    s_add_u32 s92, s91, 7168
    s_and_b32 s92, s92, 32767
    buffer_load_dwordx4 v[68:71], v1, s[48:51], s92 offen nt
    s_lshl_b32 s85, s15, 10
    s_add_u32 m0, s85, 98304
    s_movk_i32 s85, 1280
    buffer_load_dwordx4 v34, s[56:59], s85 offen  lds
    s_waitcnt vmcnt(3)
    s_cbranch_vccnz L_kw_5
    s_waitcnt vmcnt(2)
L_kw_5:
    s_add_u32 s92, s91, 8192
    s_and_b32 s92, s92, 32767
    buffer_load_dwordx4 v[72:75], v1, s[48:51], s92 offen nt
    s_waitcnt vmcnt(3)
    s_cbranch_vccnz L_kw_6
    s_waitcnt vmcnt(2)
L_kw_6:
    s_add_u32 s92, s91, 9216
    s_and_b32 s92, s92, 32767
    buffer_load_dwordx4 v[76:79], v1, s[48:51], s92 offen nt
    s_waitcnt vmcnt(3)
    s_cbranch_vccnz L_kw_7
    s_waitcnt vmcnt(2)
L_kw_7:
    s_mov_b64 exec, 1
    v_mov_b32 v14, 1
    ds_add_u32 v13, v14 offset:48
    s_mov_b64 exec, -1
    s_add_u32 s92, s91, 10240
    s_and_b32 s92, s92, 32767
    buffer_load_dwordx4 v[80:83], v1, s[48:51], s92 offen nt
    s_lshl_b32 s85, s15, 10
    s_add_u32 m0, s85, 106496
    s_movk_i32 s85, 256
    buffer_load_dwordx4 v34, s[56:59], s85 offen  lds
    s_waitcnt vmcnt(3)
    s_cbranch_vccnz L_kw_8
    s_waitcnt vmcnt(2)
L_kw_8:
    s_add_u32 s92, s91, 11264
    s_and_b32 s92, s92, 32767
    buffer_load_dwordx4 v[84:87], v1, s[48:51], s92 offen nt
    s_waitcnt vmcnt(3)
    s_cbranch_vccnz L_kw_9
    s_waitcnt vmcnt(2)
L_kw_9:
    s_add_u32 s92, s91, 12288
    s_and_b32 s92, s92, 32767
    buffer_load_dwordx4 v[88:91], v1, s[48:51], s92 offen nt
    v_readfirstlane_b32 s94, v35
    s_nop 0
    s_mul_i32 s94, s94, 1664525
    s_add_u32 s94, s94, 1013904223
    s_waitcnt vmcnt(3)
    s_cbranch_vccnz L_kw_10
    s_waitcnt vmcnt(2)
L_kw_10:
    s_add_u32 s92, s91, 13312
    s_and_b32 s92, s92, 32767
    buffer_load_dwordx4 v[92:95], v1, s[48:51], s92 offen nt
    s_lshl_b32 s85, s15, 10
    s_add_u32 m0, s85, 114688
    s_movk_i32 s85, 1536
    buffer_load_dwordx4 v34, s[56:59], s85 offen  lds
    s_waitcnt vmcnt(3)
    s_cbranch_vccnz L_kw_11
    s_waitcnt vmcnt(2)
L_kw_11:
    s_add_u32 s92, s91, 14336
    s_and_b32 s92, s92, 32767
    buffer_load_dwordx4 v[96:99], v1, s[48:51], s92 offen nt
    s_waitcnt vmcnt(3)
    s_cbranch_vccnz L_kw_12
    s_waitcnt vmcnt(2)
L_kw_12:
    s_add_u32 s92, s91, 15360
    s_and_b32 s92, s92, 32767
    buffer_load_dwordx4 v[100:103], v1, s[48:51], s92 offen nt
    s_waitcnt vmcnt(3)
    s_cbranch_vccnz L_kw_13
    s_waitcnt vmcnt(2)
L_kw_13:
    s_add_u32 s92, s91, 16384
    s_and_b32 s92, s92, 32767
    buffer_load_dwordx4 v[104:107], v1, s[48:51], s92 offen nt
    s_lshl_b32 s85, s15, 10
    s_add_u32 m0, s85, 122880
    s_movk_i32 s85, 512
    buffer_load_dwordx4 v34, s[56:59], s85 offen  lds
    s_waitcnt vmcnt(3)
    s_cbranch_vccnz L_kw_14
    s_waitcnt vmcnt(2)
L_kw_14:
    s_add_u32 s92, s91, 17408
    s_and_b32 s92, s92, 32767
    buffer_load_dwordx4 v[108:111], v1, s[48:51], s92 offen nt
    s_waitcnt vmcnt(3)
    s_cbranch_vccnz L_kw_15
    s_waitcnt vmcnt(2)
L_kw_15:
    s_add_u32 s92, s91, 18432
    s_and_b32 s92, s92, 32767
    buffer_load_dwordx4 v[112:115], v1, s[48:51], s92 offen nt
    s_waitcnt vmcnt(3)
    s_cbranch_vccnz L_kw_16
    s_waitcnt vmcnt(2)
L_kw_16:
    s_add_u32 s92, s91, 19456
    s_and_b32 s92, s92, 32767
    buffer_load_dwordx4 v[116:119], v1, s[48:51], s92 offen nt
    s_lshl_b32 s85, s15, 10
    s_add_u32 m0, s85, 131072
    s_movk_i32 s85, 1792
    buffer_load_dwordx4 v34, s[56:59], s85 offen  lds
    s_waitcnt vmcnt(3)
    s_cbranch_vccnz L_kw_17
    s_waitcnt vmcnt(2)
L_kw_17:
    s_add_u32 s92, s91, 20480
    s_and_b32 s92, s92, 32767
    buffer_load_dwordx4 v[120:123], v1, s[48:51], s92 offen nt
    s_waitcnt vmcnt(3)
    s_cbranch_vccnz L_kw_18
    s_waitcnt vmcnt(2)
L_kw_18:
    s_add_u32 s92, s91, 21504
    s_and_b32 s92, s92, 32767
    buffer_load_dwordx4 v[124:127], v1, s[48:51], s92 offen nt
    s_waitcnt vmcnt(3)
    s_cbranch_vccnz L_kw_19
    s_waitcnt vmcnt(2)
L_kw_19:
    s_add_u32 s92, s91, 22528
    s_and_b32 s92, s92, 32767
    buffer_load_dwordx4 v[128:131], v1, s[48:51], s92 offen nt
    s_cmp_lg_u32 s7, 1
    s_cbranch_scc1 L_stg_ok
    s_mov_b32 s89, 1048576
L_lw_20:
    ds_read_b32 v14, v13 offset:0
    s_waitcnt lgkmcnt(0)
    v_readfirstlane_b32 s88, v14
    s_nop 0
    s_cmp_ge_u32 s88, 4
    s_cbranch_scc1 L_lwd_21
    s_sleep 1
    s_sub_u32 s89, s89, 1
    s_cbranch_scc0 L_lw_20
L_lwd_21:
L_stg_ok:
    s_lshl_b32 s85, s15, 10
    s_add_u32 m0, s85, 139264
    s_movk_i32 s85, 768
    buffer_load_dwordx4 v34, s[56:59], s85 offen  lds
    s_waitcnt vmcnt(3)
    s_cbranch_vccnz L_kw_22
    s_waitcnt vmcnt(2)
L_kw_22:
    s_add_u32 s92, s91, 23552
    s_and_b32 s92, s92, 32767
    buffer_load_dwordx4 v[132:135], v1, s[48:51], s92 offen nt
    s_waitcnt vmcnt(3)
    s_cbranch_vccnz L_kw_23
    s_waitcnt vmcnt(2)
L_kw_23:
    s_add_u32 s92, s91, 24576
    s_and_b32 s92, s92, 32767
    buffer_load_dwordx4 v[136:139], v1, s[48:51], s92 offen nt
    s_waitcnt vmcnt(3)
    s_cbranch_vccnz L_kw_24
    s_waitcnt vmcnt(2)
L_kw_24:
    s_add_u32 s92, s91, 25600
    s_and_b32 s92, s92, 32767
    buffer_load_dwordx4 v[140:143], v1, s[48:51], s92 offen nt
    s_lshl_b32 s85, s15, 10
    s_add_u32 m0, s85, 147456
    s_movk_i32 s85, 2048
    buffer_load_dwordx4 v34, s[56:59], s85 offen  lds
    s_waitcnt vmcnt(3)
    s_cbranch_vccnz L_kw_25
    s_waitcnt vmcnt(2)
L_kw_25:
    s_add_u32 s92, s91, 26624
    s_and_b32 s92, s92, 32767
    buffer_load_dwordx4 v[144:147], v1, s[48:51], s92 offen nt
    s_waitcnt vmcnt(3)
    s_cbranch_vccnz L_kw_26
    s_waitcnt vmcnt(2)
L_kw_26:
    s_add_u32 s92, s91, 27648
    s_and_b32 s92, s92, 32767
    buffer_load_dwordx4 v[148:151], v1, s[48:51], s92 offen nt
    s_waitcnt vmcnt(3)
    s_cbranch_vccnz L_kw_27
    s_waitcnt vmcnt(2)
L_kw_27:
    s_add_u32 s92, s91, 28672
    s_and_b32 s92, s92, 32767
    buffer_load_dwordx4 v[152:155], v1, s[48:51], s92 offen nt
    s_lshl_b32 s85, s15, 10
    s_add_u32 m0, s85, 155648
    s_movk_i32 s85, 1024
    buffer_load_dwordx4 v34, s[56:59], s85 offen  lds
    buffer_load_dwordx4 v[4:7], v12, s[44:47], s93 offen sc1
    buffer_load_dwordx4 v[16:19], v12, s[44:47], s93 offen offset:16 sc1
    s_waitcnt vmcnt(3)
    s_cbranch_vccnz L_kw_28
    s_waitcnt vmcnt(2)
L_kw_28:
    s_add_u32 s92, s91, 29696
    s_and_b32 s92, s92, 32767
    buffer_load_dwordx4 v[156:159], v1, s[48:51], s92 offen nt
    s_waitcnt vmcnt(3)
    s_cbranch_vccnz L_kw_29
    s_waitcnt vmcnt(2)
L_kw_29:
    s_add_u32 s92, s91, 30720
    s_and_b32 s92, s92, 32767
    buffer_load_dwordx4 v[160:163], v1, s[48:51], s92 offen nt
    s_waitcnt vmcnt(3)
    s_cbranch_vccnz L_kw_30
    s_waitcnt vmcnt(2)
L_kw_30:
    s_add_u32 s92, s91, 31744
    s_and_b32 s92, s92, 32767
    buffer_load_dwordx4 v[164:167], v1, s[48:51], s92 offen nt
    s_waitcnt vmcnt(3)
    s_mov_b32 s89, 65536
    s_waitcnt lgkmcnt(0)
    s_mov_b32 s63, 0
L_q_chk:
    v_xor_b32 v20, s94, v5
    v_xor_b32 v21, s94, v7
    v_xor_b32 v22, s94, v17
    v_xor_b32 v23, s94, v19
    v_or_b32 v20, v20, v21
    v_or3_b32 v20, v20, v22, v23
    v_cmp_ne_u32 vcc, 0, v20
    s_cbranch_vccz L_q_ok
    s_cmp_ge_u32 s63, 24576
    s_cbranch_scc1 L_q_nopf
    s_add_u32 s85, s91, s63
    v_lshl_add_u32 v38, v2, 7, s85
    v_and_b32 v38, 0x7fff, v38
    s_lshl_b32 s85, s15, 15
    buffer_load_dword v39, v38, s[52:55], s85 offen
    s_addk_i32 s63, 8192
L_q_nopf:
    buffer_load_dwordx4 v[4:7], v12, s[44:47], s93 offen sc1
    buffer_load_dwordx4 v[16:19], v12, s[44:47], s93 offen offset:16 sc1
    s_waitcnt vmcnt(0)
    s_sub_u32 s89, s89, 1
    s_cbranch_scc0 L_q_chk
L_q_ok:
    v_mov_b32 v5, v6
    v_mov_b32 v6, v16
    v_mov_b32 v7, v18
    s_mov_b64 exec, 1
    v_mov_b32 v14, 1
    ds_add_u32 v13, v14 offset:16
    s_mov_b64 exec, -1
    s_movk_i32 s60, 1280
    s_movk_i32 s61, 2560
    s_movk_i32 s62, 3840
    s_waitcnt vmcnt(39)
    v_dot2_f32_bf16 v20, v40, v4, 0
    v_dot2_f32_bf16 v21, v44, v4, 0
    v_dot2_f32_bf16 v22, v48, v4, 0
    v_dot2_f32_bf16 v23, v52, v4, 0
    v_dot2_f32_bf16 v20, v41, v5, v20
    v_dot2_f32_bf16 v21, v45, v5, v21
    v_dot2_f32_bf16 v22, v49, v5, v22
    v_dot2_f32_bf16 v23, v53, v5, v23
    v_dot2_f32_bf16 v20, v42, v6, v20
    v_dot2_f32_bf16 v21, v46, v6, v21
    v_dot2_f32_bf16 v22, v50, v6, v22
    v_dot2_f32_bf16 v23, v54, v6, v23
    v_dot2_f32_bf16 v20, v43, v7, v20
    v_dot2_f32_bf16 v21, v47, v7, v21
    v_dot2_f32_bf16 v22, v51, v7, v22
    v_dot2_f32_bf16 v23, v55, v7, v23
    s_add_u32 s92, s91, 0
    s_and_b32 s92, s92, 32767
    buffer_load_dwordx4 v[40:43], v1, s[52:55], s92 offen nt
    v_add_f32_dpp v24, v20, v20 row_ror:8 row_mask:0xf bank_mask:0x3
    v_add_f32_dpp v25, v22, v22 row_ror:8 row_mask:0xf bank_mask:0x3
    s_nop 0
    v_add_f32_dpp v24, v21, v21 row_ror:8 row_mask:0xf bank_mask:0xc
    v_add_f32_dpp v25, v23, v23 row_ror:8 row_mask:0xf bank_mask:0xc
    s_nop 0
    v_add_f32_dpp v26, v24, v24 row_shl:4 row_mask:0xf bank_mask:0x5
    s_nop 1
    v_add_f32_dpp v26, v25, v25 row_shr:4 row_mask:0xf bank_mask:0xa
    s_waitcnt vmcnt(35)
    v_dot2_f32_bf16 v20, v56, v4, 0
    v_dot2_f32_bf16 v21, v60, v4, 0
    v_dot2_f32_bf16 v22, v64, v4, 0
    v_dot2_f32_bf16 v23, v68, v4, 0
    v_dot2_f32_bf16 v20, v57, v5, v20
    v_dot2_f32_bf16 v21, v61, v5, v21
    v_dot2_f32_bf16 v22, v65, v5, v22
    v_dot2_f32_bf16 v23, v69, v5, v23
    v_dot2_f32_bf16 v20, v58, v6, v20
    v_dot2_f32_bf16 v21, v62, v6, v21
    v_dot2_f32_bf16 v22, v66, v6, v22
    v_dot2_f32_bf16 v23, v70, v6, v23
    v_dot2_f32_bf16 v20, v59, v7, v20
    v_dot2_f32_bf16 v21, v63, v7, v21
    v_dot2_f32_bf16 v22, v67, v7, v22
    v_dot2_f32_bf16 v23, v71, v7, v23
    s_add_u32 s92, s91, 1024
    s_and_b32 s92, s92, 32767
    buffer_load_dwordx4 v[44:47], v1, s[52:55], s92 offen nt
    v_add_f32_dpp v24, v20, v20 row_ror:8 row_mask:0xf bank_mask:0x3
    v_add_f32_dpp v25, v22, v22 row_ror:8 row_mask:0xf bank_mask:0x3
    s_nop 0
    v_add_f32_dpp v24, v21, v21 row_ror:8 row_mask:0xf bank_mask:0xc
    v_add_f32_dpp v25, v23, v23 row_ror:8 row_mask:0xf bank_mask:0xc
    s_nop 0
    v_add_f32_dpp v27, v24, v24 row_shl:4 row_mask:0xf bank_mask:0x5
    s_nop 1
    v_add_f32_dpp v27, v25, v25 row_shr:4 row_mask:0xf bank_mask:0xa
    v_add_f32_dpp v30, v26, v26 quad_perm:[2,3,0,1] row_mask:0xf bank_mask:0xf
    s_nop 0
    v_add_f32_dpp v31, v27, v27 quad_perm:[2,3,0,1] row_mask:0xf bank_mask:0xf
    v_cndmask_b32 v28, v30, v31, s[96:97]
    s_waitcnt vmcnt(30)
    v_dot2_f32_bf16 v20, v72, v4, 0
    v_dot2_f32_bf16 v21, v76, v4, 0
    v_dot2_f32_bf16 v22, v80, v4, 0
    v_dot2_f32_bf16 v23, v84, v4, 0
    v_dot2_f32_bf16 v20, v73, v5, v20
    v_dot2_f32_bf16 v21, v77, v5, v21
    v_dot2_f32_bf16 v22, v81, v5, v22
    v_dot2_f32_bf16 v23, v85, v5, v23
    v_dot2_f32_bf16 v20, v74, v6, v20
    v_dot2_f32_bf16 v21, v78, v6, v21
    v_dot2_f32_bf16 v22, v82, v6, v22
    v_dot2_f32_bf16 v23, v86, v6, v23
    v_dot2_f32_bf16 v20, v75, v7, v20
    v_dot2_f32_bf16 v21, v79, v7, v21
    v_dot2_f32_bf16 v22, v83, v7, v22
    v_dot2_f32_bf16 v23, v87, v7, v23
    s_add_u32 s92, s91, 2048
    s_and_b32 s92, s92, 32767
    buffer_load_dwordx4 v[48:51], v1, s[52:55], s92 offen nt
    v_add_f32_dpp v24, v20, v20 row_ror:8 row_mask:0xf bank_mask:0x3
    v_add_f32_dpp v25, v22, v22 row_ror:8 row_mask:0xf bank_mask:0x3
    s_nop 0
    v_add_f32_dpp v24, v21, v21 row_ror:8 row_mask:0xf bank_mask:0xc
    v_add_f32_dpp v25, v23, v23 row_ror:8 row_mask:0xf bank_mask:0xc
    s_nop 0
    v_add_f32_dpp v26, v24, v24 row_shl:4 row_mask:0xf bank_mask:0x5
    s_nop 1
    v_add_f32_dpp v26, v25, v25 row_shr:4 row_mask:0xf bank_mask:0xa
    s_waitcnt vmcnt(26)
    v_dot2_f32_bf16 v20, v88, v4, 0
    v_dot2_f32_bf16 v21, v92, v4, 0
    v_dot2_f32_bf16 v22, v96, v4, 0
    v_dot2_f32_bf16 v23, v100, v4, 0
    v_dot2_f32_bf16 v20, v89, v5, v20
    v_dot2_f32_bf16 v21, v93, v5, v21
    v_dot2_f32_bf16 v22, v97, v5, v22
    v_dot2_f32_bf16 v23, v101, v5, v23
    v_dot2_f32_bf16 v20, v90, v6, v20
    v_dot2_f32_bf16 v21, v94, v6, v21
    v_dot2_f32_bf16 v22, v98, v6, v22
    v_dot2_f32_bf16 v23, v102, v6, v23
    v_dot2_f32_bf16 v20, v91, v7, v20
    v_dot2_f32_bf16 v21, v95, v7, v21
    v_dot2_f32_bf16 v22, v99, v7, v22
    v_dot2_f32_bf16 v23, v103, v7, v23
    s_add_u32 s92, s91, 3072
    s_and_b32 s92, s92, 32767
    buffer_load_dwordx4 v[52:55], v1, s[52:55], s92 offen nt
    v_add_f32_dpp v24, v20, v20 row_ror:8 row_mask:0xf bank_mask:0x3
    v_add_f32_dpp v25, v22, v22 row_ror:8 row_mask:0xf bank_mask:0x3
    s_nop 0
    v_add_f32_dpp v24, v21, v21 row_ror:8 row_mask:0xf bank_mask:0xc
    v_add_f32_dpp v25, v23, v23 row_ror:8 row_mask:0xf bank_mask:0xc
    s_nop 0
    v_add_f32_dpp v27, v24, v24 row_shl:4 row_mask:0xf bank_mask:0x5
    s_nop 1
    v_add_f32_dpp v27, v25, v25 row_shr:4 row_mask:0xf bank_mask:0xa
    v_add_f32_dpp v30, v26, v26 quad_perm:[2,3,0,1] row_mask:0xf bank_mask:0xf
    s_nop 0
    v_add_f32_dpp v31, v27, v27 quad_perm:[2,3,0,1] row_mask:0xf bank_mask:0xf
    v_cndmask_b32 v29, v30, v31, s[96:97]
    v_add_f32_dpp v30, v28, v28 quad_perm:[1,0,3,2] row_mask:0xf bank_mask:0xf
    s_nop 0
    v_add_f32_dpp v31, v29, v29 quad_perm:[1,0,3,2] row_mask:0xf bank_mask:0xf
    v_cndmask_b32 v32, v30, v31, s[98:99]
    s_waitcnt vmcnt(22)
    v_dot2_f32_bf16 v20, v104, v4, 0
    v_dot2_f32_bf16 v21, v108, v4, 0
    v_dot2_f32_bf16 v22, v112, v4, 0
    v_dot2_f32_bf16 v23, v116, v4, 0
    v_dot2_f32_bf16 v20, v105, v5, v20
    v_dot2_f32_bf16 v21, v109, v5, v21
    v_dot2_f32_bf16 v22, v113, v5, v22
    v_dot2_f32_bf16 v23, v117, v5, v23
    v_dot2_f32_bf16 v20, v106, v6, v20
    v_dot2_f32_bf16 v21, v110, v6, v21
    v_dot2_f32_bf16 v22, v114, v6, v22
    v_dot2_f32_bf16 v23, v118, v6, v23
    v_dot2_f32_bf16 v20, v107, v7, v20
    v_dot2_f32_bf16 v21, v111, v7, v21
    v_dot2_f32_bf16 v22, v115, v7, v22
    v_dot2_f32_bf16 v23, v119, v7, v23
    s_add_u32 s92, s91, 4096
    s_and_b32 s92, s92, 32767
    buffer_load_dwordx4 v[56:59], v1, s[52:55], s92 offen nt
    v_add_f32_dpp v24, v20, v20 row_ror:8 row_mask:0xf bank_mask:0x3
    v_add_f32_dpp v25, v22, v22 row_ror:8 row_mask:0xf bank_mask:0x3
    s_nop 0
    v_add_f32_dpp v24, v21, v21 row_ror:8 row_mask:0xf bank_mask:0xc
    v_add_f32_dpp v25, v23, v23 row_ror:8 row_mask:0xf bank_mask:0xc
    s_nop 0
    v_add_f32_dpp v26, v24, v24 row_shl:4 row_mask:0xf bank_mask:0x5
    s_nop 1
    v_add_f32_dpp v26, v25, v25 row_shr:4 row_mask:0xf bank_mask:0xa
    s_waitcnt vmcnt(17)
    v_dot2_f32_bf16 v20, v120, v4, 0
    v_dot2_f32_bf16 v21, v124, v4, 0
    v_dot2_f32_bf16 v22, v128, v4, 0
    v_dot2_f32_bf16 v23, v132, v4, 0
    v_dot2_f32_bf16 v20, v121, v5, v20
    v_dot2_f32_bf16 v21, v125, v5, v21
    v_dot2_f32_bf16 v22, v129, v5, v22
    v_dot2_f32_bf16 v23, v133, v5, v23
    v_dot2_f32_bf16 v20, v122, v6, v20
    v_dot2_f32_bf16 v21, v126, v6, v21
    v_dot2_f32_bf16 v22, v130, v6, v22
    v_dot2_f32_bf16 v23, v134, v6, v23
    v_dot2_f32_bf16 v20, v123, v7, v20
    v_dot2_f32_bf16 v21, v127, v7, v21
    v_dot2_f32_bf16 v22, v131, v7, v22
    v_dot2_f32_bf16 v23, v135, v7, v23
    s_add_u32 s92, s91, 5120
    s_and_b32 s92, s92, 32767
    buffer_load_dwordx4 v[60:63], v1, s[52:55], s92 offen nt
    v_add_f32_dpp v24, v20, v20 row_ror:8 row_mask:0xf bank_mask:0x3
    v_add_f32_dpp v25, v22, v22 row_ror:8 row_mask:0xf bank_mask:0x3
    s_nop 0
    v_add_f32_dpp v24, v21, v21 row_ror:8 row_mask:0xf bank_mask:0xc
    v_add_f32_dpp v25, v23, v23 row_ror:8 row_mask:0xf bank_mask:0xc
    s_nop 0
    v_add_f32_dpp v27, v24, v24 row_shl:4 row_mask:0xf bank_mask:0x5
    s_nop 1
    v_add_f32_dpp v27, v25, v25 row_shr:4 row_mask:0xf bank_mask:0xa
    v_add_f32_dpp v30, v26, v26 quad_perm:[2,3,0,1] row_mask:0xf bank_mask:0xf
    s_nop 0
    v_add_f32_dpp v31, v27, v27 quad_perm:[2,3,0,1] row_mask:0xf bank_mask:0xf
    v_cndmask_b32 v28, v30, v31, s[96:97]
    s_waitcnt vmcnt(13)
    v_dot2_f32_bf16 v20, v136, v4, 0
    v_dot2_f32_bf16 v21, v140, v4, 0
    v_dot2_f32_bf16 v22, v144, v4, 0
    v_dot2_f32_bf16 v23, v148, v4, 0
    v_dot2_f32_bf16 v20, v137, v5, v20
    v_dot2_f32_bf16 v21, v141, v5, v21
    v_dot2_f32_bf16 v22, v145, v5, v22
    v_dot2_f32_bf16 v23, v149, v5, v23
    v_dot2_f32_bf16 v20, v138, v6, v20
    v_dot2_f32_bf16 v21, v142, v6, v21
    v_dot2_f32_bf16 v22, v146, v6, v22
    v_dot2_f32_bf16 v23, v150, v6, v23
    v_dot2_f32_bf16 v20, v139, v7, v20
    v_dot2_f32_bf16 v21, v143, v7, v21
    v_dot2_f32_bf16 v22, v147, v7, v22
    v_dot2_f32_bf16 v23, v151, v7, v23
    s_add_u32 s92, s91, 6144
    s_and_b32 s92, s92, 32767
    buffer_load_dwordx4 v[64:67], v1, s[52:55], s92 offen nt
    v_add_f32_dpp v24, v20, v20 row_ror:8 row_mask:0xf bank_mask:0x3
    v_add_f32_dpp v25, v22, v22 row_ror:8 row_mask:0xf bank_mask:0x3
    s_nop 0
    v_add_f32_dpp v24, v21, v21 row_ror:8 row_mask:0xf bank_mask:0xc
    v_add_f32_dpp v25, v23, v23 row_ror:8 row_mask:0xf bank_mask:0xc
    s_nop 0
    v_add_f32_dpp v26, v24, v24 row_shl:4 row_mask:0xf bank_mask:0x5
    s_nop 1
    v_add_f32_dpp v26, v25, v25 row_shr:4 row_mask:0xf bank_mask:0xa
    s_waitcnt vmcnt(7)
    v_dot2_f32_bf16 v20, v152, v4, 0
    v_dot2_f32_bf16 v21, v156, v4, 0
    v_dot2_f32_bf16 v22, v160, v4, 0
    v_dot2_f32_bf16 v23, v164, v4, 0
    v_dot2_f32_bf16 v20, v153, v5, v20
    v_dot2_f32_bf16 v21, v157, v5, v21
    v_dot2_f32_bf16 v22, v161, v5, v22
    v_dot2_f32_bf16 v23, v165, v5, v23
    v_dot2_f32_bf16 v20, v154, v6, v20
    v_dot2_f32_bf16 v21, v158, v6, v21
    v_dot2_f32_bf16 v22, v162, v6, v22
    v_dot2_f32_bf16 v23, v166, v6, v23
    v_dot2_f32_bf16 v20, v155, v7, v20
    v_dot2_f32_bf16 v21, v159, v7, v21
    v_dot2_f32_bf16 v22, v163, v7, v22
    v_dot2_f32_bf16 v23, v167, v7, v23
    s_add_u32 s92, s91, 7168
    s_and_b32 s92, s92, 32767
    buffer_load_dwordx4 v[68:71], v1, s[52:55], s92 offen nt
    v_add_f32_dpp v24, v20, v20 row_ror:8 row_mask:0xf bank_mask:0x3
    v_add_f32_dpp v25, v22, v22 row_ror:8 row_mask:0xf bank_mask:0x3
    s_nop 0
    v_add_f32_dpp v24, v21, v21 row_ror:8 row_mask:0xf bank_mask:0xc
    v_add_f32_dpp v25, v23, v23 row_ror:8 row_mask:0xf bank_mask:0xc
    s_nop 0
    v_add_f32_dpp v27, v24, v24 row_shl:4 row_mask:0xf bank_mask:0x5
    s_nop 1
    v_add_f32_dpp v27, v25, v25 row_shr:4 row_mask:0xf bank_mask:0xa
    v_add_f32_dpp v30, v26, v26 quad_perm:[2,3,0,1] row_mask:0xf bank_mask:0xf
    s_nop 0
    v_add_f32_dpp v31, v27, v27 quad_perm:[2,3,0,1] row_mask:0xf bank_mask:0xf
    v_cndmask_b32 v29, v30, v31, s[96:97]
    v_add_f32_dpp v30, v28, v28 quad_perm:[1,0,3,2] row_mask:0xf bank_mask:0xf
    s_nop 0
    v_add_f32_dpp v31, v29, v29 quad_perm:[1,0,3,2] row_mask:0xf bank_mask:0xf
    v_cndmask_b32 v33, v30, v31, s[98:99]
    v_cvt_pk_bf16_f32 v20, v32, v33
    s_mov_b32 s86, 0x3db504f3
    v_lshlrev_b32 v32, 16, v20
    v_and_b32 v33, s84, v20
    v_pk_mul_f32 v[32:33], v[32:33], s[86:87] op_sel_hi:[1,0]
    v_cvt_pk_bf16_f32 v20, v32, v33
    v_lshlrev_b32 v32, 16, v20
    v_and_b32 v33, s84, v20
    v_max_f32 v20, v32, v33
    s_nop 1
    v_max_f32_dpp v20, v20, v20 row_ror:8 row_mask:0xf bank_mask:0xf
    s_nop 1
    v_max_f32_dpp v20, v20, v20 row_ror:4 row_mask:0xf bank_mask:0xf
    s_nop 1
    v_max_f32_dpp v20, v20, v20 row_ror:2 row_mask:0xf bank_mask:0xf
    s_nop 1
    v_max_f32_dpp v20, v20, v20 row_ror:1 row_mask:0xf bank_mask:0xf
    s_nop 1
    v_max_f32_dpp v20, v20, v20 row_bcast:15 row_mask:0xa bank_mask:0xf
    s_nop 1
    v_max_f32_dpp v20, v20, v20 row_bcast:31 row_mask:0xc bank_mask:0xf
    s_nop 0
    v_readlane_b32 s86, v20, 63
    s_mov_b32 s90, 1069066811
    s_nop 0
    v_subrev_f32 v20, s86, v32
    v_subrev_f32 v21, s86, v33
    v_mul_f32 v20, s90, v20
    v_mul_f32 v21, s90, v21
    v_exp_f32 v20, v20
    v_exp_f32 v21, v21
    s_nop 0
    v_add_f32 v21, v20, v21
    s_nop 1
    v_add_f32_dpp v21, v21, v21 row_ror:8 row_mask:0xf bank_mask:0xf
    s_nop 1
    v_add_f32_dpp v21, v21, v21 row_ror:4 row_mask:0xf bank_mask:0xf
    s_nop 1
    v_add_f32_dpp v21, v21, v21 row_ror:2 row_mask:0xf bank_mask:0xf
    s_nop 1
    v_add_f32_dpp v21, v21, v21 row_ror:1 row_mask:0xf bank_mask:0xf
    s_nop 1
    v_add_f32_dpp v21, v21, v21 row_bcast:15 row_mask:0xa bank_mask:0xf
    s_nop 1
    v_add_f32_dpp v21, v21, v21 row_bcast:31 row_mask:0xc bank_mask:0xf
    v_mov_b32 v20, s86
    s_lshl_b32 s85, s15, 3
    v_add_u32 v22, s85, v13
    s_mov_b32 exec_lo, 0
    s_mov_b32 exec_hi, 0x80000000
    ds_write_b64 v22, v[20:21] offset:256
    s_mov_b64 exec, -1
    s_lshl_b32 s85, s15, 10
    s_add_u32 s85, s85, 90112
    v_lshl_add_u32 v36, v2, 4, s85
    v_add_u32 v37, 32768, v36
    ds_read_b128 v[88:91], v36 offset:0
    ds_read_b128 v[92:95], v36 offset:8192
    ds_read_b128 v[96:99], v36 offset:16384
    ds_read_b128 v[100:103], v36 offset:24576
    ds_read_b128 v[104:107], v37 offset:0
    ds_read_b128 v[108:111], v37 offset:8192
    ds_read_b128 v[112:115], v37 offset:16384
    ds_read_b128 v[116:119], v37 offset:24576
    ds_read_b128 v[120:123], v37 offset:32768
    s_mov_b64 exec, 1
    v_mov_b32 v14, 1
    ds_add_u32 v13, v14 offset:4
    s_mov_b64 exec, -1
    buffer_load_dwordx4 v[124:127], v34, s[56:59], s60 offen offset:1024
    s_mov_b32 s89, 1048576
L_lw_31:
    ds_read_b32 v14, v13 offset:4
    s_waitcnt lgkmcnt(0)
    v_readfirstlane_b32 s88, v14
    s_nop 0
    s_cmp_ge_u32 s88, 8
    s_cbranch_scc1 L_lwd_32
    s_sub_u32 s89, s89, 1
    s_cbranch_scc0 L_lw_31
L_lwd_32:
    v_and_b32 v22, 7, v2
    v_lshl_add_u32 v22, v22, 3, v13
    ds_read_b64 v[20:21], v22 offset:256
    s_lshr_b32 s63, 0, s7
    s_and_b32 s63, s63, 1
    s_waitcnt lgkmcnt(0)
    v_max_f32_dpp v22, v20, v20 row_ror:4 row_mask:0xf bank_mask:0xf
    s_nop 1
    v_max_f32_dpp v22, v22, v22 row_ror:2 row_mask:0xf bank_mask:0xf
    s_nop 1
    v_max_f32_dpp v22, v22, v22 row_ror:1 row_mask:0xf bank_mask:0xf
    v_sub_f32 v20, v20, v22
    v_mul_f32 v20, s90, v20
    v_exp_f32 v20, v20
    v_sub_f32 v32, v32, v22
    v_sub_f32 v33, v33, v22
    v_mul_f32 v21, v21, v20
    v_mul_f32 v32, s90, v32
    v_mul_f32 v33, s90, v33
    v_add_f32_dpp v21, v21, v21 row_ror:4 row_mask:0xf bank_mask:0xf
    v_exp_f32 v32, v32
    v_exp_f32 v33, v33
    v_add_f32_dpp v21, v21, v21 row_ror:2 row_mask:0xf bank_mask:0xf
    s_nop 1
    v_add_f32_dpp v21, v21, v21 row_ror:1 row_mask:0xf bank_mask:0xf
    v_rcp_f32 v21, v21
    s_nop 0
    v_mul_f32 v32, v32, v21
    v_mul_f32 v33, v33, v21
    v_cvt_pk_bf16_f32 v32, v32, v32
    v_cvt_pk_bf16_f32 v33, v33, v33
    s_nop 0
    v_and_b32_dpp v20, v32, v8 row_newbcast:0 row_mask:0xf bank_mask:0xf
    v_and_b32_dpp v21, v32, v9 row_newbcast:0 row_mask:0xf bank_mask:0xf
    v_and_b32_dpp v22, v32, v10 row_newbcast:0 row_mask:0xf bank_mask:0xf
    v_and_b32_dpp v23, v32, v11 row_newbcast:0 row_mask:0xf bank_mask:0xf
    s_waitcnt vmcnt(8)
    s_nop 0
    v_mfma_f32_16x16x32_bf16 v[16:19], v[20:23], v[40:43], 0
    buffer_load_dwordx4 v[128:131], v34, s[56:59], s61 offen offset:0
    v_and_b32_dpp v24, v32, v8 row_newbcast:8 row_mask:0xf bank_mask:0xf
    v_and_b32_dpp v25, v32, v9 row_newbcast:8 row_mask:0xf bank_mask:0xf
    v_and_b32_dpp v26, v32, v10 row_newbcast:8 row_mask:0xf bank_mask:0xf
    v_and_b32_dpp v27, v32, v11 row_newbcast:8 row_mask:0xf bank_mask:0xf
    s_waitcnt vmcnt(8)
    s_nop 0
    v_mfma_f32_16x16x32_bf16 v[16:19], v[24:27], v[44:47], v[16:19]
    buffer_load_dwordx4 v[132:135], v34, s[56:59], s62 offen offset:0
    v_and_b32_dpp v20, v32, v8 row_newbcast:4 row_mask:0xf bank_mask:0xf
    v_and_b32_dpp v21, v32, v9 row_newbcast:4 row_mask:0xf bank_mask:0xf
    v_and_b32_dpp v22, v32, v10 row_newbcast:4 row_mask:0xf bank_mask:0xf
    v_and_b32_dpp v23, v32, v11 row_newbcast:4 row_mask:0xf bank_mask:0xf
    s_waitcnt vmcnt(8)
    s_nop 0
    v_mfma_f32_16x16x32_bf16 v[16:19], v[20:23], v[48:51], v[16:19]
    buffer_load_dwordx4 v[136:139], v34, s[56:59], s61 offen offset:256
    v_and_b32_dpp v24, v32, v8 row_newbcast:12 row_mask:0xf bank_mask:0xf
    v_and_b32_dpp v25, v32, v9 row_newbcast:12 row_mask:0xf bank_mask:0xf
    v_and_b32_dpp v26, v32, v10 row_newbcast:12 row_mask:0xf bank_mask:0xf
    v_and_b32_dpp v27, v32, v11 row_newbcast:12 row_mask:0xf bank_mask:0xf
    s_waitcnt vmcnt(8)
    s_nop 0
    v_mfma_f32_16x16x32_bf16 v[16:19], v[24:27], v[52:55], v[16:19]
    buffer_load_dwordx4 v[140:143], v34, s[56:59], s62 offen offset:256
    v_and_b32_dpp v20, v32, v8 row_newbcast:2 row_mask:0xf bank_mask:0xf
    v_and_b32_dpp v21, v32, v9 row_newbcast:2 row_mask:0xf bank_mask:0xf
    v_and_b32_dpp v22, v32, v10 row_newbcast:2 row_mask:0xf bank_mask:0xf
    v_and_b32_dpp v23, v32, v11 row_newbcast:2 row_mask:0xf bank_mask:0xf
    s_waitcnt vmcnt(8)
    s_nop 0
    v_mfma_f32_16x16x32_bf16 v[16:19], v[20:23], v[56:59], v[16:19]
    s_add_u32 s92, s91, 8192
    s_and_b32 s92, s92, 32767
    buffer_load_dwordx4 v[72:75], v1, s[52:55], s92 offen nt
    buffer_load_dwordx4 v[144:147], v34, s[56:59], s61 offen offset:512
    v_and_b32_dpp v24, v32, v8 row_newbcast:10 row_mask:0xf bank_mask:0xf
    v_and_b32_dpp v25, v32, v9 row_newbcast:10 row_mask:0xf bank_mask:0xf
    v_and_b32_dpp v26, v32, v10 row_newbcast:10 row_mask:0xf bank_mask:0xf
    v_and_b32_dpp v27, v32, v11 row_newbcast:10 row_mask:0xf bank_mask:0xf
    s_waitcnt vmcnt(9)
    s_nop 0
    v_mfma_f32_16x16x32_bf16 v[16:19], v[24:27], v[60:63], v[16:19]
    s_add_u32 s92, s91, 9216
    s_and_b32 s92, s92, 32767
    buffer_load_dwordx4 v[76:79], v1, s[52:55], s92 offen nt
    buffer_load_dwordx4 v[148:151], v34, s[56:59], s62 offen offset:512
    v_and_b32_dpp v20, v32, v8 row_newbcast:6 row_mask:0xf bank_mask:0xf
    v_and_b32_dpp v21, v32, v9 row_newbcast:6 row_mask:0xf bank_mask:0xf
    v_and_b32_dpp v22, v32, v10 row_newbcast:6 row_mask:0xf bank_mask:0xf
    v_and_b32_dpp v23, v32, v11 row_newbcast:6 row_mask:0xf bank_mask:0xf
    s_waitcnt vmcnt(10)
    s_nop 0
    v_mfma_f32_16x16x32_bf16 v[16:19], v[20:23], v[64:67], v[16:19]
    s_add_u32 s92, s91, 10240
    s_and_b32 s92, s92, 32767
    buffer_load_dwordx4 v[80:83], v1, s[52:55], s92 offen nt
    buffer_load_dwordx4 v[152:155], v34, s[56:59], s61 offen offset:768
    v_and_b32_dpp v24, v32, v8 row_newbcast:14 row_mask:0xf bank_mask:0xf
    v_and_b32_dpp v25, v32, v9 row_newbcast:14 row_mask:0xf bank_mask:0xf
    v_and_b32_dpp v26, v32, v10 row_newbcast:14 row_mask:0xf bank_mask:0xf
    v_and_b32_dpp v27, v32, v11 row_newbcast:14 row_mask:0xf bank_mask:0xf
    s_waitcnt vmcnt(11)
    s_nop 0
    v_mfma_f32_16x16x32_bf16 v[16:19], v[24:27], v[68:71], v[16:19]
    s_add_u32 s92, s91, 11264
    s_and_b32 s92, s92, 32767
    buffer_load_dwordx4 v[84:87], v1, s[52:55], s92 offen nt
    buffer_load_dwordx4 v[156:159], v34, s[56:59], s62 offen offset:768
    v_and_b32_dpp v20, v32, v8 row_newbcast:1 row_mask:0xf bank_mask:0xf
    v_and_b32_dpp v21, v32, v9 row_newbcast:1 row_mask:0xf bank_mask:0xf
    v_and_b32_dpp v22, v32, v10 row_newbcast:1 row_mask:0xf bank_mask:0xf
    v_and_b32_dpp v23, v32, v11 row_newbcast:1 row_mask:0xf bank_mask:0xf
    s_waitcnt vmcnt(7)
    s_nop 0
    v_mfma_f32_16x16x32_bf16 v[16:19], v[20:23], v[72:75], v[16:19]
    s_add_u32 s92, s91, 12288
    s_and_b32 s92, s92, 32767
    buffer_load_dwordx4 v[40:43], v1, s[52:55], s92 offen nt
    buffer_load_dwordx4 v[160:163], v34, s[56:59], s61 offen offset:1024
    v_and_b32_dpp v24, v32, v8 row_newbcast:9 row_mask:0xf bank_mask:0xf
    v_and_b32_dpp v25, v32, v9 row_newbcast:9 row_mask:0xf bank_mask:0xf
    v_and_b32_dpp v26, v32, v10 row_newbcast:9 row_mask:0xf bank_mask:0xf
    v_and_b32_dpp v27, v32, v11 row_newbcast:9 row_mask:0xf bank_mask:0xf
    s_waitcnt vmcnt(7)
    s_nop 0
    v_mfma_f32_16x16x32_bf16 v[16:19], v[24:27], v[76:79], v[16:19]
    s_add_u32 s92, s91, 13312
    s_and_b32 s92, s92, 32767
    buffer_load_dwordx4 v[44:47], v1, s[52:55], s92 offen nt
    buffer_load_dwordx4 v[164:167], v34, s[56:59], s62 offen offset:1024
    v_and_b32_dpp v20, v32, v8 row_newbcast:5 row_mask:0xf bank_mask:0xf
    v_and_b32_dpp v21, v32, v9 row_newbcast:5 row_mask:0xf bank_mask:0xf
    v_and_b32_dpp v22, v32, v10 row_newbcast:5 row_mask:0xf bank_mask:0xf
    v_and_b32_dpp v23, v32, v11 row_newbcast:5 row_mask:0xf bank_mask:0xf
    s_waitcnt vmcnt(7)
    s_nop 0
    v_mfma_f32_16x16x32_bf16 v[16:19], v[20:23], v[80:83], v[16:19]
    s_add_u32 s92, s91, 14336
    s_and_b32 s92, s92, 32767
    buffer_load_dwordx4 v[48:51], v1, s[52:55], s92 offen nt
    v_and_b32_dpp v24, v32, v8 row_newbcast:13 row_mask:0xf bank_mask:0xf
    v_and_b32_dpp v25, v32, v9 row_newbcast:13 row_mask:0xf bank_mask:0xf
    v_and_b32_dpp v26, v32, v10 row_newbcast:13 row_mask:0xf bank_mask:0xf
    v_and_b32_dpp v27, v32, v11 row_newbcast:13 row_mask:0xf bank_mask:0xf
    s_waitcnt vmcnt(6)
    s_nop 0
    v_mfma_f32_16x16x32_bf16 v[16:19], v[24:27], v[84:87], v[16:19]
    s_add_u32 s92, s91, 15360
    s_and_b32 s92, s92, 32767
    buffer_load_dwordx4 v[52:55], v1, s[52:55], s92 offen nt
    v_and_b32_dpp v20, v32, v8 row_newbcast:3 row_mask:0xf bank_mask:0xf
    v_and_b32_dpp v21, v32, v9 row_newbcast:3 row_mask:0xf bank_mask:0xf
    v_and_b32_dpp v22, v32, v10 row_newbcast:3 row_mask:0xf bank_mask:0xf
    v_and_b32_dpp v23, v32, v11 row_newbcast:3 row_mask:0xf bank_mask:0xf
    s_waitcnt vmcnt(5)
    s_nop 0
    v_mfma_f32_16x16x32_bf16 v[16:19], v[20:23], v[40:43], v[16:19]
    s_add_u32 s92, s91, 16384
    s_and_b32 s92, s92, 32767
    buffer_load_dwordx4 v[56:59], v1, s[52:55], s92 offen nt
    s_add_u32 s92, s91, 17408
    s_and_b32 s92, s92, 32767
    buffer_load_dwordx4 v[60:63], v1, s[52:55], s92 offen nt
    s_add_u32 s92, s91, 18432
    s_and_b32 s92, s92, 32767
    buffer_load_dwordx4 v[64:67], v1, s[52:55], s92 offen nt
    s_add_u32 s92, s91, 19456
    s_and_b32 s92, s92, 32767
    buffer_load_dwordx4 v[68:71], v1, s[52:55], s92 offen nt
    s_add_u32 s92, s91, 20480
    s_and_b32 s92, s92, 32767
    buffer_load_dwordx4 v[72:75], v1, s[52:55], s92 offen nt
    v_and_b32_dpp v24, v32, v8 row_newbcast:11 row_mask:0xf bank_mask:0xf
    v_and_b32_dpp v25, v32, v9 row_newbcast:11 row_mask:0xf bank_mask:0xf
    v_and_b32_dpp v26, v32, v10 row_newbcast:11 row_mask:0xf bank_mask:0xf
    v_and_b32_dpp v27, v32, v11 row_newbcast:11 row_mask:0xf bank_mask:0xf
    s_waitcnt vmcnt(8)
    s_nop 0
    v_mfma_f32_16x16x32_bf16 v[16:19], v[24:27], v[44:47], v[16:19]
    s_add_u32 s92, s91, 21504
    s_and_b32 s92, s92, 32767
    buffer_load_dwordx4 v[76:79], v1, s[52:55], s92 offen nt
    v_and_b32_dpp v20, v32, v8 row_newbcast:7 row_mask:0xf bank_mask:0xf
    v_and_b32_dpp v21, v32, v9 row_newbcast:7 row_mask:0xf bank_mask:0xf
    v_and_b32_dpp v22, v32, v10 row_newbcast:7 row_mask:0xf bank_mask:0xf
    v_and_b32_dpp v23, v32, v11 row_newbcast:7 row_mask:0xf bank_mask:0xf
    s_waitcnt vmcnt(7)
    s_nop 0
    v_mfma_f32_16x16x32_bf16 v[16:19], v[20:23], v[48:51], v[16:19]
    s_add_u32 s92, s91, 22528
    s_and_b32 s92, s92, 32767
    buffer_load_dwordx4 v[80:83], v1, s[52:55], s92 offen nt
    v_lshlrev_b32 v7, 4, v2
    v_and_b32 v3, 15, v2
    v_lshrrev_b32 v4, 4, v2
    v_lshlrev_b32 v5, 5, v3
    v_lshl_add_u32 v5, v4, 4, v5
    s_lshl_b32 s85, s15, 9
    s_add_u32 s85, s85, 86016
    v_add_u32 v6, s85, v5
    s_mul_i32 s85, s15, 2560
    s_add_u32 s85, s85, 143360
    v_add_u32 v5, s85, v7
    v_add_u32 v36, 90112, v7
    v_cmp_gt_u32 vcc, 32, v2
    s_lshl_b32 s85, s15, 6
    s_add_u32 s85, s85, 86016
    v_lshl_add_u32 v4, v4, 4, s85
    v_bfe_u32 v3, v2, 4, 1
    v_lshlrev_b32 v4, 5, v3
    v_and_b32 v3, 1, v2
    v_lshl_add_u32 v4, v3, 4, v4
    v_bfe_u32 v3, v2, 1, 1
    v_lshl_add_u32 v4, v3, 3, v4
    v_lshrrev_b32 v3, 5, v2
    v_lshl_add_u32 v4, v3, 2, v4
    v_bfe_u32 v3, v2, 2, 2
    v_lshl_add_u32 v4, v3, 10, v4
    v_add_u32 v4, s85, v4
    v_mov_b32 v37, 0xffff
    v_cmp_eq_u32 vcc, 0, v3
    s_nop 1
    v_cndmask_b32 v38, 0, v37, vcc
    v_cmp_eq_u32 vcc, 1, v3
    s_nop 1
    v_cndmask_b32 v39, 0, v37, vcc
    v_cmp_eq_u32 vcc, 2, v3
    s_nop 1
    v_cndmask_b32 v12, 0, v37, vcc
    v_cmp_eq_u32 vcc, 3, v3
    s_nop 1
    v_cndmask_b32 v0, 0, v37, vcc
    v_and_b32 v3, 3, v2
    v_mul_u32_u24 v37, 0x5555, v3
    v_mov_b32 v28, 0
    v_mov_b32 v29, 0
    v_mov_b32 v30, 0
    v_mov_b32 v31, 0
    v_bfe_u32 v35, v2, 1, 4
    v_and_b32 v36, 1, v2
    v_lshl_add_u32 v35, v36, 4, v35
    v_lshlrev_b32 v35, 4, v35
    v_lshrrev_b32 v36, 5, v2
    v_mul_u32_u24 v36, 10240, v36
    s_lshl_b32 s85, s15, 9
    s_add_u32 s86, s85, 143360
    v_add3_u32 v35, v35, v36, s86
    s_mul_i32 s87, s2, 2560
    s_add_u32 s87, s87, s85
    s_add_u32 s87, s87, 327680
    v_and_b32_dpp v24, v32, v8 row_newbcast:15 row_mask:0xf bank_mask:0xf
    v_and_b32_dpp v25, v32, v9 row_newbcast:15 row_mask:0xf bank_mask:0xf
    v_and_b32_dpp v26, v32, v10 row_newbcast:15 row_mask:0xf bank_mask:0xf
    v_and_b32_dpp v27, v32, v11 row_newbcast:15 row_mask:0xf bank_mask:0xf
    s_waitcnt vmcnt(7)
    s_nop 0
    v_mfma_f32_16x16x32_bf16 v[16:19], v[24:27], v[52:55], v[16:19]
    s_add_u32 s92, s91, 23552
    s_and_b32 s92, s92, 32767
    buffer_load_dwordx4 v[84:87], v1, s[52:55], s92 offen nt
    v_and_b32_dpp v20, v33, v8 row_newbcast:0 row_mask:0xf bank_mask:0xf
    v_and_b32_dpp v21, v33, v9 row_newbcast:0 row_mask:0xf bank_mask:0xf
    v_and_b32_dpp v22, v33, v10 row_newbcast:0 row_mask:0xf bank_mask:0xf
    v_and_b32_dpp v23, v33, v11 row_newbcast:0 row_mask:0xf bank_mask:0xf
    s_waitcnt vmcnt(7)
    s_nop 0
    v_mfma_f32_16x16x32_bf16 v[16:19], v[20:23], v[56:59], v[16:19]
    s_add_u32 s92, s91, 24576
    s_and_b32 s92, s92, 32767
    buffer_load_dwordx4 v[40:43], v1, s[52:55], s92 offen nt
    v_and_b32_dpp v24, v33, v8 row_newbcast:8 row_mask:0xf bank_mask:0xf
    v_and_b32_dpp v25, v33, v9 row_newbcast:8 row_mask:0xf bank_mask:0xf
    v_and_b32_dpp v26, v33, v10 row_newbcast:8 row_mask:0xf bank_mask:0xf
    v_and_b32_dpp v27, v33, v11 row_newbcast:8 row_mask:0xf bank_mask:0xf
    s_waitcnt vmcnt(7)
    s_nop 0
    v_mfma_f32_16x16x32_bf16 v[16:19], v[24:27], v[60:63], v[16:19]
    s_add_u32 s92, s91, 25600
    s_and_b32 s92, s92, 32767
    buffer_load_dwordx4 v[44:47], v1, s[52:55], s92 offen nt
    v_and_b32_dpp v20, v33, v8 row_newbcast:4 row_mask:0xf bank_mask:0xf
    v_and_b32_dpp v21, v33, v9 row_newbcast:4 row_mask:0xf bank_mask:0xf
    v_and_b32_dpp v22, v33, v10 row_newbcast:4 row_mask:0xf bank_mask:0xf
    v_and_b32_dpp v23, v33, v11 row_newbcast:4 row_mask:0xf bank_mask:0xf
    s_waitcnt vmcnt(7)
    s_nop 0
    v_mfma_f32_16x16x32_bf16 v[16:19], v[20:23], v[64:67], v[16:19]
    s_add_u32 s92, s91, 26624
    s_and_b32 s92, s92, 32767
    buffer_load_dwordx4 v[48:51], v1, s[52:55], s92 offen nt
    v_and_b32_dpp v24, v33, v8 row_newbcast:12 row_mask:0xf bank_mask:0xf
    v_and_b32_dpp v25, v33, v9 row_newbcast:12 row_mask:0xf bank_mask:0xf
    v_and_b32_dpp v26, v33, v10 row_newbcast:12 row_mask:0xf bank_mask:0xf
    v_and_b32_dpp v27, v33, v11 row_newbcast:12 row_mask:0xf bank_mask:0xf
    s_waitcnt vmcnt(7)
    s_nop 0
    v_mfma_f32_16x16x32_bf16 v[16:19], v[24:27], v[68:71], v[16:19]
    s_add_u32 s92, s91, 27648
    s_and_b32 s92, s92, 32767
    buffer_load_dwordx4 v[52:55], v1, s[52:55], s92 offen nt
    v_and_b32_dpp v20, v33, v8 row_newbcast:2 row_mask:0xf bank_mask:0xf
    v_and_b32_dpp v21, v33, v9 row_newbcast:2 row_mask:0xf bank_mask:0xf
    v_and_b32_dpp v22, v33, v10 row_newbcast:2 row_mask:0xf bank_mask:0xf
    v_and_b32_dpp v23, v33, v11 row_newbcast:2 row_mask:0xf bank_mask:0xf
    s_waitcnt vmcnt(7)
    s_nop 0
    v_mfma_f32_16x16x32_bf16 v[16:19], v[20:23], v[72:75], v[16:19]
    s_add_u32 s92, s91, 28672
    s_and_b32 s92, s92, 32767
    buffer_load_dwordx4 v[56:59], v1, s[52:55], s92 offen nt
    v_and_b32_dpp v24, v33, v8 row_newbcast:10 row_mask:0xf bank_mask:0xf
    v_and_b32_dpp v25, v33, v9 row_newbcast:10 row_mask:0xf bank_mask:0xf
    v_and_b32_dpp v26, v33, v10 row_newbcast:10 row_mask:0xf bank_mask:0xf
    v_and_b32_dpp v27, v33, v11 row_newbcast:10 row_mask:0xf bank_mask:0xf
    s_waitcnt vmcnt(7)
    s_nop 0
    v_mfma_f32_16x16x32_bf16 v[16:19], v[24:27], v[76:79], v[16:19]
    s_add_u32 s92, s91, 29696
    s_and_b32 s92, s92, 32767
    buffer_load_dwordx4 v[60:63], v1, s[52:55], s92 offen nt
    v_and_b32_dpp v20, v33, v8 row_newbcast:6 row_mask:0xf bank_mask:0xf
    v_and_b32_dpp v21, v33, v9 row_newbcast:6 row_mask:0xf bank_mask:0xf
    v_and_b32_dpp v22, v33, v10 row_newbcast:6 row_mask:0xf bank_mask:0xf
    v_and_b32_dpp v23, v33, v11 row_newbcast:6 row_mask:0xf bank_mask:0xf
    s_waitcnt vmcnt(7)
    s_nop 0
    v_mfma_f32_16x16x32_bf16 v[16:19], v[20:23], v[80:83], v[16:19]
    s_add_u32 s92, s91, 30720
    s_and_b32 s92, s92, 32767
    buffer_load_dwordx4 v[64:67], v1, s[52:55], s92 offen nt
    s_mov_b64 exec, 1
    v_mov_b32 v14, 1
    ds_add_u32 v13, v14 offset:20
    s_mov_b64 exec, -1
    v_and_b32_dpp v24, v33, v8 row_newbcast:14 row_mask:0xf bank_mask:0xf
    v_and_b32_dpp v25, v33, v9 row_newbcast:14 row_mask:0xf bank_mask:0xf
    v_and_b32_dpp v26, v33, v10 row_newbcast:14 row_mask:0xf bank_mask:0xf
    v_and_b32_dpp v27, v33, v11 row_newbcast:14 row_mask:0xf bank_mask:0xf
    s_waitcnt vmcnt(7)
    s_nop 0
    v_mfma_f32_16x16x32_bf16 v[16:19], v[24:27], v[84:87], v[16:19]
    s_add_u32 s92, s91, 31744
    s_and_b32 s92, s92, 32767
    buffer_load_dwordx4 v[68:71], v1, s[52:55], s92 offen nt
    v_and_b32_dpp v20, v33, v8 row_newbcast:1 row_mask:0xf bank_mask:0xf
    v_and_b32_dpp v21, v33, v9 row_newbcast:1 row_mask:0xf bank_mask:0xf
    v_and_b32_dpp v22, v33, v10 row_newbcast:1 row_mask:0xf bank_mask:0xf
    v_and_b32_dpp v23, v33, v11 row_newbcast:1 row_mask:0xf bank_mask:0xf
    s_waitcnt vmcnt(7)
    s_nop 0
    v_mfma_f32_16x16x32_bf16 v[16:19], v[20:23], v[40:43], v[16:19]
    v_mov_b32 v72, 0
    v_mov_b32 v73, 0
    v_mov_b32 v74, 0
    v_mov_b32 v75, 0
    v_and_b32_dpp v24, v33, v8 row_newbcast:9 row_mask:0xf bank_mask:0xf
    v_and_b32_dpp v25, v33, v9 row_newbcast:9 row_mask:0xf bank_mask:0xf
    v_and_b32_dpp v26, v33, v10 row_newbcast:9 row_mask:0xf bank_mask:0xf
    v_and_b32_dpp v27, v33, v11 row_newbcast:9 row_mask:0xf bank_mask:0xf
    s_waitcnt vmcnt(6)
    s_nop 0
    v_mfma_f32_16x16x32_bf16 v[16:19], v[24:27], v[44:47], v[16:19]
    v_mov_b32 v76, 0
    v_mov_b32 v77, 0
    v_mov_b32 v78, 0
    v_mov_b32 v79, 0
    v_and_b32_dpp v20, v33, v8 row_newbcast:5 row_mask:0xf bank_mask:0xf
    v_and_b32_dpp v21, v33, v9 row_newbcast:5 row_mask:0xf bank_mask:0xf
    v_and_b32_dpp v22, v33, v10 row_newbcast:5 row_mask:0xf bank_mask:0xf
    v_and_b32_dpp v23, v33, v11 row_newbcast:5 row_mask:0xf bank_mask:0xf
    s_waitcnt vmcnt(5)
    s_nop 0
    v_mfma_f32_16x16x32_bf16 v[16:19], v[20:23], v[48:51], v[16:19]
    v_mov_b32 v80, 0
    v_mov_b32 v81, 0
    v_mov_b32 v82, 0
    v_mov_b32 v83, 0
    v_and_b32_dpp v24, v33, v8 row_newbcast:13 row_mask:0xf bank_mask:0xf
    v_and_b32_dpp v25, v33, v9 row_newbcast:13 row_mask:0xf bank_mask:0xf
    v_and_b32_dpp v26, v33, v10 row_newbcast:13 row_mask:0xf bank_mask:0xf
    v_and_b32_dpp v27, v33, v11 row_newbcast:13 row_mask:0xf bank_mask:0xf
    s_waitcnt vmcnt(4)
    s_nop 0
    v_mfma_f32_16x16x32_bf16 v[16:19], v[24:27], v[52:55], v[16:19]
    s_mov_b64 exec, 1
    v_mov_b32 v14, 1
    ds_add_u32 v13, v14 offset:36
    s_mov_b64 exec, -1
    v_mov_b32 v84, 0
    v_mov_b32 v85, 0
    v_mov_b32 v86, 0
    v_mov_b32 v87, 0
    v_and_b32_dpp v20, v33, v8 row_newbcast:3 row_mask:0xf bank_mask:0xf
    v_and_b32_dpp v21, v33, v9 row_newbcast:3 row_mask:0xf bank_mask:0xf
    v_and_b32_dpp v22, v33, v10 row_newbcast:3 row_mask:0xf bank_mask:0xf
    v_and_b32_dpp v23, v33, v11 row_newbcast:3 row_mask:0xf bank_mask:0xf
    s_waitcnt vmcnt(3)
    s_nop 0
    v_mfma_f32_16x16x32_bf16 v[16:19], v[20:23], v[56:59], v[16:19]
    v_and_b32_dpp v24, v33, v8 row_newbcast:11 row_mask:0xf bank_mask:0xf
    v_and_b32_dpp v25, v33, v9 row_newbcast:11 row_mask:0xf bank_mask:0xf
    v_and_b32_dpp v26, v33, v10 row_newbcast:11 row_mask:0xf bank_mask:0xf
    v_and_b32_dpp v27, v33, v11 row_newbcast:11 row_mask:0xf bank_mask:0xf
    s_waitcnt vmcnt(2)
    s_nop 0
    v_mfma_f32_16x16x32_bf16 v[16:19], v[24:27], v[60:63], v[16:19]
    v_and_b32_dpp v20, v33, v8 row_newbcast:7 row_mask:0xf bank_mask:0xf
    v_and_b32_dpp v21, v33, v9 row_newbcast:7 row_mask:0xf bank_mask:0xf
    v_and_b32_dpp v22, v33, v10 row_newbcast:7 row_mask:0xf bank_mask:0xf
    v_and_b32_dpp v23, v33, v11 row_newbcast:7 row_mask:0xf bank_mask:0xf
    s_waitcnt vmcnt(1)
    s_nop 0
    v_mfma_f32_16x16x32_bf16 v[16:19], v[20:23], v[64:67], v[16:19]
    v_and_b32_dpp v24, v33, v8 row_newbcast:15 row_mask:0xf bank_mask:0xf
    v_and_b32_dpp v25, v33, v9 row_newbcast:15 row_mask:0xf bank_mask:0xf
    v_and_b32_dpp v26, v33, v10 row_newbcast:15 row_mask:0xf bank_mask:0xf
    v_and_b32_dpp v27, v33, v11 row_newbcast:15 row_mask:0xf bank_mask:0xf
    s_waitcnt vmcnt(0)
    s_nop 0
    v_mfma_f32_16x16x32_bf16 v[16:19], v[24:27], v[68:71], v[16:19]
    s_mov_b32 exec_hi, 0
    s_nop 6
    ds_write_b128 v6, v[16:19]
    s_mov_b64 exec, -1
    s_cmp_eq_u32 s7, 6
    s_cbranch_scc1 L_s1_spin
    s_waitcnt lgkmcnt(0)
    s_barrier
L_tail_dry:
    ds_read2_b32 v[40:41], v4 offset0:0 offset1:128
    s_waitcnt lgkmcnt(0)
L_s1_done:
    v_add_f32 v40, v40, v41
    s_nop 1
    v_add_f32_dpp v40, v40, v40 row_ror:4 row_mask:0xf bank_mask:0xf
    s_nop 1
    v_add_f32_dpp v40, v40, v40 row_ror:8 row_mask:0xf bank_mask:0xf
    v_cvt_pk_bf16_f32 v40, v40, v40
    s_nop 1
    v_and_b32_dpp v20, v40, v38 quad_perm:[0,0,0,0] row_mask:0xf bank_mask:0xf
    v_and_b32_dpp v21, v40, v39 quad_perm:[0,0,0,0] row_mask:0xf bank_mask:0xf
    v_and_b32_dpp v22, v40, v38 quad_perm:[1,1,1,1] row_mask:0xf bank_mask:0xf
    v_and_b32_dpp v23, v40, v39 quad_perm:[1,1,1,1] row_mask:0xf bank_mask:0xf
    v_and_b32_dpp v24, v40, v38 quad_perm:[2,2,2,2] row_mask:0xf bank_mask:0xf
    v_and_b32_dpp v25, v40, v39 quad_perm:[2,2,2,2] row_mask:0xf bank_mask:0xf
    v_and_b32_dpp v26, v40, v38 quad_perm:[3,3,3,3] row_mask:0xf bank_mask:0xf
    v_and_b32_dpp v27, v40, v39 quad_perm:[3,3,3,3] row_mask:0xf bank_mask:0xf
    v_smfmac_f32_16x16x64_bf16 v[80:83], v[20:23], v[120:127], v37
    v_smfmac_f32_16x16x64_bf16 v[72:75], v[20:23], v[88:95], v37
    v_and_b32_dpp v44, v40, v12 quad_perm:[0,0,0,0] row_mask:0xf bank_mask:0xf
    v_and_b32_dpp v45, v40, v0 quad_perm:[0,0,0,0] row_mask:0xf bank_mask:0xf
    v_and_b32_dpp v46, v40, v12 quad_perm:[1,1,1,1] row_mask:0xf bank_mask:0xf
    v_and_b32_dpp v47, v40, v0 quad_perm:[1,1,1,1] row_mask:0xf bank_mask:0xf
    v_smfmac_f32_16x16x64_bf16 v[80:83], v[24:27], v[160:167], v37
    v_smfmac_f32_16x16x64_bf16 v[76:79], v[20:23], v[104:111], v37
    v_and_b32_dpp v48, v40, v12 quad_perm:[2,2,2,2] row_mask:0xf bank_mask:0xf
    v_and_b32_dpp v49, v40, v0 quad_perm:[2,2,2,2] row_mask:0xf bank_mask:0xf
    v_and_b32_dpp v50, v40, v12 quad_perm:[3,3,3,3] row_mask:0xf bank_mask:0xf
    v_and_b32_dpp v51, v40, v0 quad_perm:[3,3,3,3] row_mask:0xf bank_mask:0xf
    v_smfmac_f32_16x16x64_bf16 v[72:75], v[24:27], v[128:135], v37
    v_smfmac_f32_16x16x64_bf16 v[76:79], v[24:27], v[144:151], v37
    v_smfmac_f32_16x16x64_bf16 v[72:75], v[44:47], v[96:103], v37
    v_smfmac_f32_16x16x64_bf16 v[76:79], v[44:47], v[112:119], v37
    s_mov_b32 exec_hi, 0
    ds_write_b128 v5, v[80:83] offset:2048
    s_mov_b32 exec_hi, -1
    v_smfmac_f32_16x16x64_bf16 v[72:75], v[48:51], v[136:143], v37
    v_smfmac_f32_16x16x64_bf16 v[76:79], v[48:51], v[152:159], v37
    s_nop 6
    ds_write_b128 v5, v[72:75]
    ds_write_b128 v5, v[76:79] offset:1024
    s_cmp_eq_u32 s7, 6
    s_cbranch_scc1 L_s2_spin
    s_waitcnt lgkmcnt(0)
    s_barrier
    s_cmp_ge_u32 s15, 5
    s_cbranch_scc1 L_stream_end
L_s2_skip:
    ds_read_b128 v[40:43], v35 offset:0
    ds_read_b128 v[44:47], v35 offset:2560
    ds_read_b128 v[48:51], v35 offset:5120
    ds_read_b128 v[52:55], v35 offset:7680
    s_waitcnt lgkmcnt(0)
L_s2_done:
    v_pk_add_f32 v[40:41], v[40:41], v[44:45]
    v_pk_add_f32 v[42:43], v[42:43], v[46:47]
    v_pk_add_f32 v[48:49], v[48:49], v[52:53]
    v_pk_add_f32 v[50:51], v[50:51], v[54:55]
    v_pk_add_f32 v[40:41], v[40:41], v[48:49]
    v_pk_add_f32 v[42:43], v[42:43], v[50:51]
    v_mov_b32 v44, v40
    v_mov_b32 v45, v41
    v_mov_b32 v46, v42
    v_mov_b32 v47, v43
    v_permlane32_swap_b32 v40, v44
    v_permlane32_swap_b32 v41, v45
    v_permlane32_swap_b32 v42, v46
    v_permlane32_swap_b32 v43, v47
    v_pk_add_f32 v[40:41], v[40:41], v[44:45]
    v_pk_add_f32 v[42:43], v[42:43], v[46:47]
    v_min_u32 v40, -2, v40
    v_min_u32 v41, -2, v41
    v_min_u32 v42, -2, v42
    v_min_u32 v43, -2, v43
    s_mov_b32 exec_hi, 0
    buffer_store_dwordx4 v[40:43], v7, s[44:47], s87 offen sc1
    s_mov_b64 exec, -1
    s_mov_b64 exec, 1
    v_mov_b32 v14, 1
    ds_add_u32 v13, v14 offset:32
    s_mov_b64 exec, -1
L_stream_end:
L_end:
    s_endpgm
L_s1_spin:
    s_mov_b64 exec, 1
    v_mov_b32 v14, 1
    ds_add_u32 v13, v14 offset:8
    s_mov_b64 exec, -1
    ds_read_b32 v14, v13 offset:8
    ds_read2_b32 v[40:41], v4 offset0:0 offset1:128
    s_mov_b32 s89, 1048576
    s_waitcnt lgkmcnt(1)
    v_readfirstlane_b32 s88, v14
    s_nop 0
    s_cmp_ge_u32 s88, 8
    s_cbranch_scc1 L_w2d_34
L_w2_33:
    ds_read_b32 v14, v13 offset:8
    s_sub_u32 s89, s89, 1
    s_cbranch_scc1 L_w2r_35
    s_waitcnt lgkmcnt(0)
    v_readfirstlane_b32 s88, v14
    s_nop 0
    s_cmp_lt_u32 s88, 8
    s_cbranch_scc1 L_w2_33
L_w2r_35:
    ds_read2_b32 v[40:41], v4 offset0:0 offset1:128
L_w2d_34:
    s_waitcnt lgkmcnt(0)
    s_branch L_s1_done
L_s2_spin:
    s_mov_b64 exec, 1
    v_mov_b32 v14, 1
    ds_add_u32 v13, v14 offset:12
    s_mov_b64 exec, -1
    s_cmp_ge_u32 s15, 5
    s_cbranch_scc1 L_stream_end
    ds_read_b32 v14, v13 offset:12
    ds_read_b128 v[40:43], v35 offset:0
    ds_read_b128 v[44:47], v35 offset:2560
    ds_read_b128 v[48:51], v35 offset:5120
    ds_read_b128 v[52:55], v35 offset:7680
    s_mov_b32 s89, 1048576
    s_waitcnt lgkmcnt(4)
    v_readfirstlane_b32 s88, v14
    s_nop 0
    s_cmp_ge_u32 s88, 8
    s_cbranch_scc1 L_w2d_37
L_w2_36:
    ds_read_b32 v14, v13 offset:12
    s_sub_u32 s89, s89, 1
    s_cbranch_scc1 L_w2r_38
    s_waitcnt lgkmcnt(0)
    v_readfirstlane_b32 s88, v14
    s_nop 0
    s_cmp_lt_u32 s88, 8
    s_cbranch_scc1 L_w2_36
L_w2r_38:
    ds_read_b128 v[40:43], v35 offset:0
    ds_read_b128 v[44:47], v35 offset:2560
    ds_read_b128 v[48:51], v35 offset:5120
    ds_read_b128 v[52:55], v35 offset:7680
L_w2d_37:
    s_waitcnt lgkmcnt(0)
    s_branch L_s2_done
L_control:
    s_setprio 3
    v_mov_b32 v13, 81920
    s_mov_b32 s84, 0xffff0000
    v_mov_b32 v15, 0
    s_lshr_b32 s13, s2, 5
    s_and_b32 s14, s2, 31
    v_add_u32 v14, v7, v13
    v_mov_b32 v16, 0
    v_mov_b32 v17, 0
    v_mov_b32 v18, 0
    v_mov_b32 v19, 0
    ds_write_b128 v14, v[16:19]
    s_and_b32 s4, s2, 7
    s_lshr_b32 s5, s2, 3
    s_mov_b32 s7, 0
    s_mov_b32 s8, 0
    s_sub_u32 s9, s5, 0
    s_mul_i32 s10, s4, 2
    s_add_u32 s10, s10, s9
    s_cmp_lt_u32 s9, 2
    s_cselect_b32 s7, 1, s7
    s_cselect_b32 s8, s10, s8
    s_sub_u32 s9, s5, 6
    s_mul_i32 s10, s4, 8
    s_add_u32 s10, s10, s9
    s_cmp_lt_u32 s9, 8
    s_cselect_b32 s7, 4, s7
    s_cselect_b32 s8, s10, s8
    s_sub_u32 s9, s5, 14
    s_mul_i32 s10, s4, 5
    s_add_u32 s10, s10, s9
    s_cmp_lt_u32 s9, 5
    s_cselect_b32 s7, 5, s7
    s_cselect_b32 s8, s10, s8
    s_sub_u32 s9, s5, 19
    s_mul_i32 s10, s4, 6
    s_add_u32 s10, s10, s9
    s_cmp_lt_u32 s9, 6
    s_cselect_b32 s7, 3, s7
    s_cselect_b32 s8, s10, s8
    s_sub_u32 s9, s5, 25
    s_mul_i32 s10, s4, 4
    s_add_u32 s10, s10, s9
    s_cmp_lt_u32 s9, 4
    s_cselect_b32 s7, 2, s7
    s_cselect_b32 s8, s10, s8
    s_sub_u32 s9, s5, 29
    s_mul_i32 s10, s4, 1
    s_add_u32 s10, s10, s9
    s_cmp_lt_u32 s9, 1
    s_cselect_b32 s7, 6, s7
    s_cselect_b32 s8, s10, s8
    s_sub_u32 s9, s5, 2
    s_lshr_b32 s10, s9, 1
    s_and_b32 s10, s10, 1
    s_lshl_b32 s11, s4, 1
    s_add_u32 s10, s10, s11
    s_lshl_b32 s10, s10, 2
    s_mov_b32 s86, 15336802
    s_mov_b32 s87, 11599987
    s_lshr_b64 s[86:87], s[86:87], s10
    s_and_b32 s10, s86, 3
    s_bfe_u32 s11, s86, 0x20002
    s_lshl_b32 s11, s11, 1
    s_lshl_b32 s12, s10, 4
    s_add_u32 s11, s11, s12
    s_and_b32 s12, s9, 1
    s_add_u32 s11, s11, s12
    s_cmp_lt_u32 s9, 4
    s_cselect_b32 s7, s10, s7
    s_cselect_b32 s8, s11, s8
    s_sub_u32 s9, s5, 19
    s_cmp_lt_u32 s9, 10
    s_cselect_b32 s6, s9, 99
    s_sub_u32 s10, s5, 20
    s_cmp_ge_u32 s5, 30
    s_cselect_b32 s6, s10, s6
    s_sub_u32 s9, s5, 2
    s_add_u32 s10, s9, 12
    s_cmp_lt_u32 s9, 4
    s_cselect_b32 s6, s10, s6
    s_waitcnt lgkmcnt(0)
    s_barrier
    s_mov_b32 s44, s42
    s_mov_b32 s45, s43
    s_mov_b32 s46, 2097152
    s_mov_b32 s47, 0x20000
    s_mov_b32 s64, s36
    s_mov_b32 s65, s37
    s_mov_b32 s66, 4915200
    s_mov_b32 s67, 0x20000
    s_mov_b32 s90, s6
    s_cmp_ge_u32 s90, 16
    s_cbranch_scc1 L_pf_done
    s_lshl_b32 s92, s4, 7
    s_cmp_lt_u32 s3, 2
    s_cbranch_scc1 L_pfA
    s_cmp_eq_u32 s4, 6
    s_cselect_b32 s92, 1024, 0
    s_cmp_eq_u32 s4, 1
    s_cselect_b32 s92, 1152, s92
    s_cmp_eq_u32 s92, 0
    s_cbranch_scc1 L_pf_done
L_pfA:
    s_lshl_b32 s90, s90, 1
    s_and_b32 s91, s3, 1
    s_add_u32 s90, s90, s91
    s_mul_i32 s91, s90, 153600
    s_add_u32 s92, s92, s91
    v_lshrrev_b32 v16, 1, v2
    v_min_u32 v16, 19, v16
    v_mul_u32_u24 v16, 7680, v16
    v_and_b32 v17, 1, v2
    v_mul_u32_u24 v17, 1280, v17
    v_add_u32 v16, v16, v17
    buffer_load_dword v160, v16, s[64:67], s92 offen
L_pf_done:
    s_cmp_eq_u32 s7, 1
    s_cbranch_scc1 L_pb_done
    s_cmp_ge_u32 s6, 16
    s_cbranch_scc1 L_pb_done
    s_mul_i32 s90, s6, 40
    s_and_b32 s91, s3, 1
    s_mul_i32 s91, s91, 24
    s_add_u32 s90, s90, s91
    v_lshrrev_b32 v16, 3, v2
    v_and_b32 v17, 7, v2
    s_cmp_lt_u32 s3, 2
    s_cbranch_scc1 L_pb3
    s_mov_b32 s64, s22
    s_mov_b32 s65, s23
    s_mov_b32 s66, 5242880
    s_mov_b32 s67, 0x20000
    v_lshlrev_b32 v17, 7, v17
    v_lshl_add_u32 v18, v16, 13, v17
    s_lshl_b32 s91, s90, 13
    s_lshl_b32 s92, s4, 10
    s_add_u32 s92, s92, s91
    s_mov_b32 s91, 65536
    s_branch L_pb4
L_pb3:
    s_mov_b32 s64, s36
    s_mov_b32 s65, s37
    s_mov_b32 s66, 4915200
    s_mov_b32 s67, 0x20000
    v_min_u32 v17, 4, v17
    v_lshlrev_b32 v17, 7, v17
    v_mul_u32_u24 v18, 7680, v16
    v_add_u32 v18, v18, v17
    s_mul_i32 s91, s90, 7680
    s_mul_i32 s92, s4, 640
    s_add_u32 s92, s92, 2560
    s_add_u32 s92, s92, s91
    s_mov_b32 s91, 61440
    s_mov_b32 s89, 1048576
L_lw_39:
    ds_read_b32 v14, v13 offset:44
    s_waitcnt lgkmcnt(0)
    v_readfirstlane_b32 s88, v14
    s_nop 0
    s_cmp_ge_u32 s88, 1
    s_cbranch_scc1 L_lwd_40
    s_sleep 2
    s_sub_u32 s89, s89, 1
    s_cbranch_scc0 L_lw_39
L_lwd_40:
L_pb4:
    buffer_load_dword v160, v18, s[64:67], s92 offen
    s_add_u32 s92, s92, s91
    buffer_load_dword v160, v18, s[64:67], s92 offen
    s_add_u32 s92, s92, s91
    s_bitcmp1_b32 s3, 0
    s_cbranch_scc1 L_pb_done
    buffer_load_dword v160, v18, s[64:67], s92 offen
L_pb_done:
    v_mov_b32 v3, 0
    buffer_load_dword v167, v3, s[44:47], 0 offen sc1
    s_mul_i32 s87, s3, 20480
    v_lshrrev_b32 v16, 4, v2
    v_bfe_u32 v17, v2, 2, 2
    v_and_b32 v18, 3, v2
    v_lshl_add_u32 v19, v16, 3, v17
    v_lshlrev_b32 v9, 7, v19
    v_lshl_add_u32 v9, v18, 3, v9
    v_add_u32 v9, s87, v9
    v_add_u32 v10, s87, v7
    v_and_b32 v17, 7, v2
    v_bfe_u32 v18, v2, 3, 1
    v_lshlrev_b32 v11, 8, v16
    v_lshl_add_u32 v11, v17, 4, v11
    v_lshl_add_u32 v11, v18, 10, v11
    v_mul_u32_u24 v19, 1280, v17
    v_lshl_add_u32 v6, v16, 4, v19
    v_lshlrev_b32 v8, 5, v18
    v_lshl_add_u32 v8, v16, 3, v8
    v_lshlrev_b32 v12, 2, v2
    s_cmp_eq_u32 s7, 4
    s_cbranch_scc1 L_role_q
    s_cmp_eq_u32 s7, 0
    s_cbranch_scc1 L_share
    s_cmp_eq_u32 s7, 3
    s_cbranch_scc1 L_share
    s_cmp_eq_u32 s7, 2
    s_cbranch_scc1 L_share
    s_cmp_eq_u32 s7, 6
    s_cbranch_scc1 L_share
    s_movk_i32 s52, 7680
    s_cmp_eq_u32 s7, 1
    s_cbranch_scc1 L_role_g1
    s_mov_b32 s56, s34
    s_mov_b32 s57, s35
    s_mov_b32 s58, 10240
    s_mov_b32 s59, 0x20000
    s_mul_i32 s85, s3, 320
    buffer_load_dwordx4 v[120:123], v6, s[56:59], s85 offen offset:0
    buffer_load_dwordx4 v[124:127], v6, s[56:59], s85 offen offset:64
    buffer_load_dwordx4 v[128:131], v6, s[56:59], s85 offen offset:128
    buffer_load_dwordx4 v[132:135], v6, s[56:59], s85 offen offset:192
    buffer_load_dwordx4 v[136:139], v6, s[56:59], s85 offen offset:256
    s_lshl_b32 s9, s8, 7
    s_add_u32 s9, s9, 2560
    s_add_u32 s48, s36, s9
    s_addc_u32 s49, s37, 0
    s_add_u32 s50, s48, 64
    s_addc_u32 s51, s49, 0
    s_waitcnt vmcnt(0)
    s_mov_b32 s85, 3216550459
    v_lshlrev_b32 v16, 16, v120
    v_and_b32 v17, s84, v120
    v_lshlrev_b32 v18, 16, v121
    v_and_b32 v19, s84, v121
    v_lshlrev_b32 v20, 16, v122
    v_and_b32 v21, s84, v122
    v_lshlrev_b32 v22, 16, v123
    v_and_b32 v23, s84, v123
    v_mul_f32 v24, s85, v16
    v_mul_f32 v25, s85, v17
    v_mul_f32 v26, s85, v18
    v_mul_f32 v27, s85, v19
    v_mul_f32 v28, s85, v20
    v_mul_f32 v29, s85, v21
    v_mul_f32 v30, s85, v22
    v_mul_f32 v31, s85, v23
    v_exp_f32 v24, v24
    v_exp_f32 v25, v25
    v_exp_f32 v26, v26
    v_exp_f32 v27, v27
    v_exp_f32 v28, v28
    v_exp_f32 v29, v29
    v_exp_f32 v30, v30
    v_exp_f32 v31, v31
    v_add_f32 v24, 1.0, v24
    v_add_f32 v25, 1.0, v25
    v_add_f32 v26, 1.0, v26
    v_add_f32 v27, 1.0, v27
    v_add_f32 v28, 1.0, v28
    v_add_f32 v29, 1.0, v29
    v_add_f32 v30, 1.0, v30
    v_add_f32 v31, 1.0, v31
    v_rcp_f32 v24, v24
    v_rcp_f32 v25, v25
    v_rcp_f32 v26, v26
    v_rcp_f32 v27, v27
    v_rcp_f32 v28, v28
    v_rcp_f32 v29, v29
    v_rcp_f32 v30, v30
    v_rcp_f32 v31, v31
    v_mul_f32 v16, v16, v24
    v_mul_f32 v17, v17, v25
    v_mul_f32 v18, v18, v26
    v_mul_f32 v19, v19, v27
    v_mul_f32 v20, v20, v28
    v_mul_f32 v21, v21, v29
    v_mul_f32 v22, v22, v30
    v_mul_f32 v23, v23, v31
    v_cvt_pk_bf16_f32 v120, v16, v17
    v_cvt_pk_bf16_f32 v121, v18, v19
    v_cvt_pk_bf16_f32 v122, v20, v21
    v_cvt_pk_bf16_f32 v123, v22, v23
    v_lshlrev_b32 v16, 16, v124
    v_and_b32 v17, s84, v124
    v_lshlrev_b32 v18, 16, v125
    v_and_b32 v19, s84, v125
    v_lshlrev_b32 v20, 16, v126
    v_and_b32 v21, s84, v126
    v_lshlrev_b32 v22, 16, v127
    v_and_b32 v23, s84, v127
    v_mul_f32 v24, s85, v16
    v_mul_f32 v25, s85, v17
    v_mul_f32 v26, s85, v18
    v_mul_f32 v27, s85, v19
    v_mul_f32 v28, s85, v20
    v_mul_f32 v29, s85, v21
    v_mul_f32 v30, s85, v22
    v_mul_f32 v31, s85, v23
    v_exp_f32 v24, v24
    v_exp_f32 v25, v25
    v_exp_f32 v26, v26
    v_exp_f32 v27, v27
    v_exp_f32 v28, v28
    v_exp_f32 v29, v29
    v_exp_f32 v30, v30
    v_exp_f32 v31, v31
    v_add_f32 v24, 1.0, v24
    v_add_f32 v25, 1.0, v25
    v_add_f32 v26, 1.0, v26
    v_add_f32 v27, 1.0, v27
    v_add_f32 v28, 1.0, v28
    v_add_f32 v29, 1.0, v29
    v_add_f32 v30, 1.0, v30
    v_add_f32 v31, 1.0, v31
    v_rcp_f32 v24, v24
    v_rcp_f32 v25, v25
    v_rcp_f32 v26, v26
    v_rcp_f32 v27, v27
    v_rcp_f32 v28, v28
    v_rcp_f32 v29, v29
    v_rcp_f32 v30, v30
    v_rcp_f32 v31, v31
    v_mul_f32 v16, v16, v24
    v_mul_f32 v17, v17, v25
    v_mul_f32 v18, v18, v26
    v_mul_f32 v19, v19, v27
    v_mul_f32 v20, v20, v28
    v_mul_f32 v21, v21, v29
    v_mul_f32 v22, v22, v30
    v_mul_f32 v23, v23, v31
    v_cvt_pk_bf16_f32 v124, v16, v17
    v_cvt_pk_bf16_f32 v125, v18, v19
    v_cvt_pk_bf16_f32 v126, v20, v21
    v_cvt_pk_bf16_f32 v127, v22, v23
    v_lshlrev_b32 v16, 16, v128
    v_and_b32 v17, s84, v128
    v_lshlrev_b32 v18, 16, v129
    v_and_b32 v19, s84, v129
    v_lshlrev_b32 v20, 16, v130
    v_and_b32 v21, s84, v130
    v_lshlrev_b32 v22, 16, v131
    v_and_b32 v23, s84, v131
    v_mul_f32 v24, s85, v16
    v_mul_f32 v25, s85, v17
    v_mul_f32 v26, s85, v18
    v_mul_f32 v27, s85, v19
    v_mul_f32 v28, s85, v20
    v_mul_f32 v29, s85, v21
    v_mul_f32 v30, s85, v22
    v_mul_f32 v31, s85, v23
    v_exp_f32 v24, v24
    v_exp_f32 v25, v25
    v_exp_f32 v26, v26
    v_exp_f32 v27, v27
    v_exp_f32 v28, v28
    v_exp_f32 v29, v29
    v_exp_f32 v30, v30
    v_exp_f32 v31, v31
    v_add_f32 v24, 1.0, v24
    v_add_f32 v25, 1.0, v25
    v_add_f32 v26, 1.0, v26
    v_add_f32 v27, 1.0, v27
    v_add_f32 v28, 1.0, v28
    v_add_f32 v29, 1.0, v29
    v_add_f32 v30, 1.0, v30
    v_add_f32 v31, 1.0, v31
    v_rcp_f32 v24, v24
    v_rcp_f32 v25, v25
    v_rcp_f32 v26, v26
    v_rcp_f32 v27, v27
    v_rcp_f32 v28, v28
    v_rcp_f32 v29, v29
    v_rcp_f32 v30, v30
    v_rcp_f32 v31, v31
    v_mul_f32 v16, v16, v24
    v_mul_f32 v17, v17, v25
    v_mul_f32 v18, v18, v26
    v_mul_f32 v19, v19, v27
    v_mul_f32 v20, v20, v28
    v_mul_f32 v21, v21, v29
    v_mul_f32 v22, v22, v30
    v_mul_f32 v23, v23, v31
    v_cvt_pk_bf16_f32 v128, v16, v17
    v_cvt_pk_bf16_f32 v129, v18, v19
    v_cvt_pk_bf16_f32 v130, v20, v21
    v_cvt_pk_bf16_f32 v131, v22, v23
    v_lshlrev_b32 v16, 16, v132
    v_and_b32 v17, s84, v132
    v_lshlrev_b32 v18, 16, v133
    v_and_b32 v19, s84, v133
    v_lshlrev_b32 v20, 16, v134
    v_and_b32 v21, s84, v134
    v_lshlrev_b32 v22, 16, v135
    v_and_b32 v23, s84, v135
    v_mul_f32 v24, s85, v16
    v_mul_f32 v25, s85, v17
    v_mul_f32 v26, s85, v18
    v_mul_f32 v27, s85, v19
    v_mul_f32 v28, s85, v20
    v_mul_f32 v29, s85, v21
    v_mul_f32 v30, s85, v22
    v_mul_f32 v31, s85, v23
    v_exp_f32 v24, v24
    v_exp_f32 v25, v25
    v_exp_f32 v26, v26
    v_exp_f32 v27, v27
    v_exp_f32 v28, v28
    v_exp_f32 v29, v29
    v_exp_f32 v30, v30
    v_exp_f32 v31, v31
    v_add_f32 v24, 1.0, v24
    v_add_f32 v25, 1.0, v25
    v_add_f32 v26, 1.0, v26
    v_add_f32 v27, 1.0, v27
    v_add_f32 v28, 1.0, v28
    v_add_f32 v29, 1.0, v29
    v_add_f32 v30, 1.0, v30
    v_add_f32 v31, 1.0, v31
    v_rcp_f32 v24, v24
    v_rcp_f32 v25, v25
    v_rcp_f32 v26, v26
    v_rcp_f32 v27, v27
    v_rcp_f32 v28, v28
    v_rcp_f32 v29, v29
    v_rcp_f32 v30, v30
    v_rcp_f32 v31, v31
    v_mul_f32 v16, v16, v24
    v_mul_f32 v17, v17, v25
    v_mul_f32 v18, v18, v26
    v_mul_f32 v19, v19, v27
    v_mul_f32 v20, v20, v28
    v_mul_f32 v21, v21, v29
    v_mul_f32 v22, v22, v30
    v_mul_f32 v23, v23, v31
    v_cvt_pk_bf16_f32 v132, v16, v17
    v_cvt_pk_bf16_f32 v133, v18, v19
    v_cvt_pk_bf16_f32 v134, v20, v21
    v_cvt_pk_bf16_f32 v135, v22, v23
    v_lshlrev_b32 v16, 16, v136
    v_and_b32 v17, s84, v136
    v_lshlrev_b32 v18, 16, v137
    v_and_b32 v19, s84, v137
    v_lshlrev_b32 v20, 16, v138
    v_and_b32 v21, s84, v138
    v_lshlrev_b32 v22, 16, v139
    v_and_b32 v23, s84, v139
    v_mul_f32 v24, s85, v16
    v_mul_f32 v25, s85, v17
    v_mul_f32 v26, s85, v18
    v_mul_f32 v27, s85, v19
    v_mul_f32 v28, s85, v20
    v_mul_f32 v29, s85, v21
    v_mul_f32 v30, s85, v22
    v_mul_f32 v31, s85, v23
    v_exp_f32 v24, v24
    v_exp_f32 v25, v25
    v_exp_f32 v26, v26
    v_exp_f32 v27, v27
    v_exp_f32 v28, v28
    v_exp_f32 v29, v29
    v_exp_f32 v30, v30
    v_exp_f32 v31, v31
    v_add_f32 v24, 1.0, v24
    v_add_f32 v25, 1.0, v25
    v_add_f32 v26, 1.0, v26
    v_add_f32 v27, 1.0, v27
    v_add_f32 v28, 1.0, v28
    v_add_f32 v29, 1.0, v29
    v_add_f32 v30, 1.0, v30
    v_add_f32 v31, 1.0, v31
    v_rcp_f32 v24, v24
    v_rcp_f32 v25, v25
    v_rcp_f32 v26, v26
    v_rcp_f32 v27, v27
    v_rcp_f32 v28, v28
    v_rcp_f32 v29, v29
    v_rcp_f32 v30, v30
    v_rcp_f32 v31, v31
    v_mul_f32 v16, v16, v24
    v_mul_f32 v17, v17, v25
    v_mul_f32 v18, v18, v26
    v_mul_f32 v19, v19, v27
    v_mul_f32 v20, v20, v28
    v_mul_f32 v21, v21, v29
    v_mul_f32 v22, v22, v30
    v_mul_f32 v23, v23, v31
    v_cvt_pk_bf16_f32 v136, v16, v17
    v_cvt_pk_bf16_f32 v137, v18, v19
    v_cvt_pk_bf16_f32 v138, v20, v21
    v_cvt_pk_bf16_f32 v139, v22, v23
    s_mov_b32 s89, 1048576
L_lw_41:
    ds_read_b32 v14, v13 offset:48
    s_waitcnt lgkmcnt(0)
    v_readfirstlane_b32 s88, v14
    s_nop 0
    s_cmp_ge_u32 s88, 1
    s_cbranch_scc1 L_lwd_42
    s_sleep 2
    s_sub_u32 s89, s89, 1
    s_cbranch_scc0 L_lw_41
L_lwd_42:
    v_lshrrev_b32 v16, 3, v2
    s_mul_i32 s85, s3, 160
    v_add_u32 v16, s85, v16
    v_mul_lo_u32 v16, s52, v16
    v_and_b32 v17, 3, v2
    v_lshl_add_u32 v16, v17, 4, v16
    v_mov_b32 v17, 0
    v_mov_b32 v18, s48
    v_mov_b32 v19, s49
    v_mov_b32 v20, s50
    v_mov_b32 v21, s51
    v_and_b32 v22, 4, v2
    v_cmp_ne_u32 vcc, 0, v22
    s_nop 1
    v_cndmask_b32 v18, v18, v20, vcc
    v_cndmask_b32 v19, v19, v21, vcc
    v_lshl_add_u64 v[4:5], v[16:17], 0, v[18:19]
    s_lshl_b32 s54, s52, 3
    s_mov_b32 s55, 0
    s_add_u32 m0, s87, 0
    s_nop 0
    global_load_lds_dwordx4 v[4:5], off
    v_lshl_add_u64 v[4:5], v[4:5], 0, s[54:55]
    s_add_u32 m0, s87, 1024
    s_nop 0
    global_load_lds_dwordx4 v[4:5], off
    v_lshl_add_u64 v[4:5], v[4:5], 0, s[54:55]
    s_add_u32 m0, s87, 2048
    s_nop 0
    global_load_lds_dwordx4 v[4:5], off
    v_lshl_add_u64 v[4:5], v[4:5], 0, s[54:55]
    s_add_u32 m0, s87, 3072
    s_nop 0
    global_load_lds_dwordx4 v[4:5], off
    v_lshl_add_u64 v[4:5], v[4:5], 0, s[54:55]
    s_add_u32 m0, s87, 4096
    s_nop 0
    global_load_lds_dwordx4 v[4:5], off
    v_lshl_add_u64 v[4:5], v[4:5], 0, s[54:55]
    s_add_u32 m0, s87, 5120
    s_nop 0
    global_load_lds_dwordx4 v[4:5], off
    v_lshl_add_u64 v[4:5], v[4:5], 0, s[54:55]
    s_add_u32 m0, s87, 6144
    s_nop 0
    global_load_lds_dwordx4 v[4:5], off
    v_lshl_add_u64 v[4:5], v[4:5], 0, s[54:55]
    s_add_u32 m0, s87, 7168
    s_nop 0
    global_load_lds_dwordx4 v[4:5], off
    v_lshl_add_u64 v[4:5], v[4:5], 0, s[54:55]
    s_add_u32 m0, s87, 8192
    s_nop 0
    global_load_lds_dwordx4 v[4:5], off
    v_lshl_add_u64 v[4:5], v[4:5], 0, s[54:55]
    s_add_u32 m0, s87, 9216
    s_nop 0
    global_load_lds_dwordx4 v[4:5], off
    v_lshl_add_u64 v[4:5], v[4:5], 0, s[54:55]
    s_add_u32 m0, s87, 10240
    s_nop 0
    global_load_lds_dwordx4 v[4:5], off
    v_lshl_add_u64 v[4:5], v[4:5], 0, s[54:55]
    s_add_u32 m0, s87, 11264
    s_nop 0
    global_load_lds_dwordx4 v[4:5], off
    v_lshl_add_u64 v[4:5], v[4:5], 0, s[54:55]
    s_add_u32 m0, s87, 12288
    s_nop 0
    global_load_lds_dwordx4 v[4:5], off
    v_lshl_add_u64 v[4:5], v[4:5], 0, s[54:55]
    s_add_u32 m0, s87, 13312
    s_nop 0
    global_load_lds_dwordx4 v[4:5], off
    v_lshl_add_u64 v[4:5], v[4:5], 0, s[54:55]
    s_add_u32 m0, s87, 14336
    s_nop 0
    global_load_lds_dwordx4 v[4:5], off
    v_lshl_add_u64 v[4:5], v[4:5], 0, s[54:55]
    s_add_u32 m0, s87, 15360
    s_nop 0
    global_load_lds_dwordx4 v[4:5], off
    v_lshl_add_u64 v[4:5], v[4:5], 0, s[54:55]
    s_add_u32 m0, s87, 16384
    s_nop 0
    global_load_lds_dwordx4 v[4:5], off
    v_lshl_add_u64 v[4:5], v[4:5], 0, s[54:55]
    s_add_u32 m0, s87, 17408
    s_nop 0
    global_load_lds_dwordx4 v[4:5], off
    v_lshl_add_u64 v[4:5], v[4:5], 0, s[54:55]
    s_add_u32 m0, s87, 18432
    s_nop 0
    global_load_lds_dwordx4 v[4:5], off
    v_lshl_add_u64 v[4:5], v[4:5], 0, s[54:55]
    s_add_u32 m0, s87, 19456
    s_nop 0
    global_load_lds_dwordx4 v[4:5], off
    s_waitcnt vmcnt(0)
    ds_read_b64_tr_b16 v[40:41], v9 offset:0
    ds_read_b64_tr_b16 v[42:43], v9 offset:512
    ds_read_b64_tr_b16 v[44:45], v9 offset:32
    ds_read_b64_tr_b16 v[46:47], v9 offset:544
    ds_read_b64_tr_b16 v[48:49], v9 offset:64
    ds_read_b64_tr_b16 v[50:51], v9 offset:576
    ds_read_b64_tr_b16 v[52:53], v9 offset:96
    ds_read_b64_tr_b16 v[54:55], v9 offset:608
    s_waitcnt lgkmcnt(0)
    ds_read_b64_tr_b16 v[56:57], v9 offset:4096
    ds_read_b64_tr_b16 v[58:59], v9 offset:4608
    ds_read_b64_tr_b16 v[60:61], v9 offset:4128
    ds_read_b64_tr_b16 v[62:63], v9 offset:4640
    ds_read_b64_tr_b16 v[64:65], v9 offset:4160
    ds_read_b64_tr_b16 v[66:67], v9 offset:4672
    ds_read_b64_tr_b16 v[68:69], v9 offset:4192
    ds_read_b64_tr_b16 v[70:71], v9 offset:4704
    s_waitcnt lgkmcnt(0)
    ds_read_b64_tr_b16 v[72:73], v9 offset:8192
    ds_read_b64_tr_b16 v[74:75], v9 offset:8704
    ds_read_b64_tr_b16 v[76:77], v9 offset:8224
    ds_read_b64_tr_b16 v[78:79], v9 offset:8736
    ds_read_b64_tr_b16 v[80:81], v9 offset:8256
    ds_read_b64_tr_b16 v[82:83], v9 offset:8768
    ds_read_b64_tr_b16 v[84:85], v9 offset:8288
    ds_read_b64_tr_b16 v[86:87], v9 offset:8800
    s_waitcnt lgkmcnt(0)
    ds_read_b64_tr_b16 v[88:89], v9 offset:12288
    ds_read_b64_tr_b16 v[90:91], v9 offset:12800
    ds_read_b64_tr_b16 v[92:93], v9 offset:12320
    ds_read_b64_tr_b16 v[94:95], v9 offset:12832
    ds_read_b64_tr_b16 v[96:97], v9 offset:12352
    ds_read_b64_tr_b16 v[98:99], v9 offset:12864
    ds_read_b64_tr_b16 v[100:101], v9 offset:12384
    ds_read_b64_tr_b16 v[102:103], v9 offset:12896
    s_waitcnt lgkmcnt(0)
    ds_read_b64_tr_b16 v[104:105], v9 offset:16384
    ds_read_b64_tr_b16 v[106:107], v9 offset:16896
    ds_read_b64_tr_b16 v[108:109], v9 offset:16416
    ds_read_b64_tr_b16 v[110:111], v9 offset:16928
    ds_read_b64_tr_b16 v[112:113], v9 offset:16448
    ds_read_b64_tr_b16 v[114:115], v9 offset:16960
    ds_read_b64_tr_b16 v[116:117], v9 offset:16480
    ds_read_b64_tr_b16 v[118:119], v9 offset:16992
    s_waitcnt lgkmcnt(0)
    v_mfma_f32_16x16x32_bf16 v[16:19], v[40:43], v[120:123], 0
    v_mfma_f32_16x16x32_bf16 v[20:23], v[44:47], v[120:123], 0
    v_mfma_f32_16x16x32_bf16 v[16:19], v[56:59], v[124:127], v[16:19]
    v_mfma_f32_16x16x32_bf16 v[20:23], v[60:63], v[124:127], v[20:23]
    v_mfma_f32_16x16x32_bf16 v[16:19], v[72:75], v[128:131], v[16:19]
    v_mfma_f32_16x16x32_bf16 v[20:23], v[76:79], v[128:131], v[20:23]
    v_mfma_f32_16x16x32_bf16 v[16:19], v[88:91], v[132:135], v[16:19]
    v_mfma_f32_16x16x32_bf16 v[20:23], v[92:95], v[132:135], v[20:23]
    v_mfma_f32_16x16x32_bf16 v[16:19], v[104:107], v[136:139], v[16:19]
    v_mfma_f32_16x16x32_bf16 v[20:23], v[108:111], v[136:139], v[20:23]
    v_mfma_f32_16x16x32_bf16 v[24:27], v[48:51], v[120:123], 0
    v_mfma_f32_16x16x32_bf16 v[28:31], v[52:55], v[120:123], 0
    v_mfma_f32_16x16x32_bf16 v[24:27], v[64:67], v[124:127], v[24:27]
    v_mfma_f32_16x16x32_bf16 v[28:31], v[68:71], v[124:127], v[28:31]
    v_mfma_f32_16x16x32_bf16 v[24:27], v[80:83], v[128:131], v[24:27]
    v_mfma_f32_16x16x32_bf16 v[28:31], v[84:87], v[128:131], v[28:31]
    v_mfma_f32_16x16x32_bf16 v[24:27], v[96:99], v[132:135], v[24:27]
    v_mfma_f32_16x16x32_bf16 v[28:31], v[100:103], v[132:135], v[28:31]
    ds_write_b128 v10, v[16:19] offset:0
    v_mfma_f32_16x16x32_bf16 v[24:27], v[112:115], v[136:139], v[24:27]
    v_mfma_f32_16x16x32_bf16 v[28:31], v[116:119], v[136:139], v[28:31]
    ds_write_b128 v10, v[20:23] offset:1024
    s_nop 5
    ds_write_b128 v10, v[24:27] offset:2048
    ds_write_b128 v10, v[28:31] offset:3072
    s_mov_b64 exec, 1
    v_mov_b32 v14, 1
    ds_add_rtn_u32 v14, v13, v14 offset:0
    s_mov_b64 exec, -1
    ds_read_b128 v[40:43], v11 offset:0
    ds_read_b128 v[56:59], v11 offset:2048
    ds_read_b128 v[44:47], v11 offset:20480
    ds_read_b128 v[60:63], v11 offset:22528
    ds_read_b128 v[48:51], v11 offset:40960
    ds_read_b128 v[64:67], v11 offset:43008
    ds_read_b128 v[52:55], v11 offset:61440
    ds_read_b128 v[68:71], v11 offset:63488
    s_waitcnt lgkmcnt(8)
    v_readfirstlane_b32 s88, v14
    s_nop 0
    s_cmp_lg_u32 s88, 3
    s_cbranch_scc1 L_ctrl_end
    v_and_b32 v22, 7, v2
    v_mul_u32_u24 v22, 5120, v22
    v_add_u32 v22, v22, v8
    s_lshl_b32 s90, s8, 7
    s_add_u32 s90, s90, 217088
    s_waitcnt lgkmcnt(0)
    v_pk_add_f32 v[40:41], v[40:41], v[44:45]
    v_pk_add_f32 v[42:43], v[42:43], v[46:47]
    v_pk_add_f32 v[48:49], v[48:49], v[52:53]
    v_pk_add_f32 v[50:51], v[50:51], v[54:55]
    v_pk_add_f32 v[40:41], v[40:41], v[48:49]
    v_pk_add_f32 v[42:43], v[42:43], v[50:51]
    v_pk_add_f32 v[56:57], v[56:57], v[60:61]
    v_pk_add_f32 v[58:59], v[58:59], v[62:63]
    v_pk_add_f32 v[64:65], v[64:65], v[68:69]
    v_pk_add_f32 v[66:67], v[66:67], v[70:71]
    v_pk_add_f32 v[56:57], v[56:57], v[64:65]
    v_pk_add_f32 v[58:59], v[58:59], v[66:67]
    v_cvt_pk_bf16_f32 v24, v40, v41
    v_cvt_pk_bf16_f32 v25, v42, v43
    v_cvt_pk_bf16_f32 v26, v56, v57
    v_cvt_pk_bf16_f32 v27, v58, v59
    v_min_u32 v24, -2, v24
    v_min_u32 v25, -2, v25
    v_min_u32 v26, -2, v26
    v_min_u32 v27, -2, v27
    s_mov_b32 s89, 1048576
L_lw_43:
    ds_read_b32 v14, v13 offset:16
    s_waitcnt lgkmcnt(0)
    v_readfirstlane_b32 s88, v14
    s_nop 0
    s_cmp_ge_u32 s88, 1
    s_cbranch_scc1 L_lwd_44
    s_sleep 8
    s_sub_u32 s89, s89, 1
    s_cbranch_scc0 L_lw_43
L_lwd_44:
    buffer_store_dwordx2 v[24:25], v22, s[44:47], s90 offen sc1
    buffer_store_dwordx2 v[26:27], v22, s[44:47], s90 offen offset:64 sc1
    s_branch L_ctrl_end
L_role_g1:
    s_lshl_b32 s9, s8, 6
    s_add_u32 s48, s36, s9
    s_addc_u32 s49, s37, 0
    s_add_u32 s50, s48, 1280
    s_addc_u32 s51, s49, 0
    v_add_u32 v34, v19, v8
    v_lshrrev_b32 v16, 3, v2
    s_mul_i32 s85, s3, 160
    v_add_u32 v16, s85, v16
    v_mul_lo_u32 v16, s52, v16
    v_and_b32 v17, 3, v2
    v_lshl_add_u32 v16, v17, 4, v16
    v_mov_b32 v17, 0
    v_mov_b32 v18, s48
    v_mov_b32 v19, s49
    v_mov_b32 v20, s50
    v_mov_b32 v21, s51
    v_and_b32 v22, 4, v2
    v_cmp_ne_u32 vcc, 0, v22
    s_nop 1
    v_cndmask_b32 v18, v18, v20, vcc
    v_cndmask_b32 v19, v19, v21, vcc
    v_lshl_add_u64 v[4:5], v[16:17], 0, v[18:19]
    s_lshl_b32 s54, s52, 3
    s_mov_b32 s55, 0
    s_mov_b32 s89, 1048576
L_lw_45:
    ds_read_b32 v14, v13 offset:52
    s_waitcnt lgkmcnt(0)
    v_readfirstlane_b32 s88, v14
    s_nop 0
    s_cmp_ge_u32 s88, 8
    s_cbranch_scc1 L_lwd_46
    s_sub_u32 s89, s89, 1
    s_cbranch_scc0 L_lw_45
L_lwd_46:
    s_add_u32 m0, s87, 0
    s_nop 0
    global_load_lds_dwordx4 v[4:5], off
    v_lshl_add_u64 v[4:5], v[4:5], 0, s[54:55]
    s_add_u32 m0, s87, 1024
    s_nop 0
    global_load_lds_dwordx4 v[4:5], off
    v_lshl_add_u64 v[4:5], v[4:5], 0, s[54:55]
    s_add_u32 m0, s87, 2048
    s_nop 0
    global_load_lds_dwordx4 v[4:5], off
    v_lshl_add_u64 v[4:5], v[4:5], 0, s[54:55]
    s_add_u32 m0, s87, 3072
    s_nop 0
    global_load_lds_dwordx4 v[4:5], off
    v_lshl_add_u64 v[4:5], v[4:5], 0, s[54:55]
    s_add_u32 m0, s87, 4096
    s_nop 0
    global_load_lds_dwordx4 v[4:5], off
    v_lshl_add_u64 v[4:5], v[4:5], 0, s[54:55]
    s_add_u32 m0, s87, 5120
    s_nop 0
    global_load_lds_dwordx4 v[4:5], off
    v_lshl_add_u64 v[4:5], v[4:5], 0, s[54:55]
    s_add_u32 m0, s87, 6144
    s_nop 0
    global_load_lds_dwordx4 v[4:5], off
    v_lshl_add_u64 v[4:5], v[4:5], 0, s[54:55]
    s_add_u32 m0, s87, 7168
    s_nop 0
    global_load_lds_dwordx4 v[4:5], off
    v_lshl_add_u64 v[4:5], v[4:5], 0, s[54:55]
    s_add_u32 m0, s87, 8192
    s_nop 0
    global_load_lds_dwordx4 v[4:5], off
    v_lshl_add_u64 v[4:5], v[4:5], 0, s[54:55]
    s_add_u32 m0, s87, 9216
    s_nop 0
    global_load_lds_dwordx4 v[4:5], off
    v_lshl_add_u64 v[4:5], v[4:5], 0, s[54:55]
    s_add_u32 m0, s87, 10240
    s_nop 0
    global_load_lds_dwordx4 v[4:5], off
    v_lshl_add_u64 v[4:5], v[4:5], 0, s[54:55]
    s_add_u32 m0, s87, 11264
    s_nop 0
    global_load_lds_dwordx4 v[4:5], off
    v_lshl_add_u64 v[4:5], v[4:5], 0, s[54:55]
    s_add_u32 m0, s87, 12288
    s_nop 0
    global_load_lds_dwordx4 v[4:5], off
    v_lshl_add_u64 v[4:5], v[4:5], 0, s[54:55]
    s_add_u32 m0, s87, 13312
    s_nop 0
    global_load_lds_dwordx4 v[4:5], off
    v_lshl_add_u64 v[4:5], v[4:5], 0, s[54:55]
    s_add_u32 m0, s87, 14336
    s_nop 0
    global_load_lds_dwordx4 v[4:5], off
    v_lshl_add_u64 v[4:5], v[4:5], 0, s[54:55]
    s_add_u32 m0, s87, 15360
    s_nop 0
    global_load_lds_dwordx4 v[4:5], off
    v_lshl_add_u64 v[4:5], v[4:5], 0, s[54:55]
    s_add_u32 m0, s87, 16384
    s_nop 0
    global_load_lds_dwordx4 v[4:5], off
    v_lshl_add_u64 v[4:5], v[4:5], 0, s[54:55]
    s_add_u32 m0, s87, 17408
    s_nop 0
    global_load_lds_dwordx4 v[4:5], off
    v_lshl_add_u64 v[4:5], v[4:5], 0, s[54:55]
    s_add_u32 m0, s87, 18432
    s_nop 0
    global_load_lds_dwordx4 v[4:5], off
    v_lshl_add_u64 v[4:5], v[4:5], 0, s[54:55]
    s_add_u32 m0, s87, 19456
    s_nop 0
    global_load_lds_dwordx4 v[4:5], off
    s_mov_b32 s60, s16
    s_mov_b32 s61, s17
    s_mov_b32 s62, 10240
    s_mov_b32 s63, 0x20000
    buffer_load_dwordx2 v[150:151], v34, s[60:63], s9 offen
    s_lshl_b32 s85, s8, 2
    s_add_u32 s85, s85, s3
    s_lshl_b32 s85, s85, 11
    s_add_u32 s85, s85, 163840
    v_mov_b32 v152, -1
    v_mov_b32 v153, -1
    v_mov_b32 v154, -1
    v_mov_b32 v155, -1
    buffer_store_dwordx4 v[152:155], v7, s[44:47], s85 offen sc1
    buffer_store_dwordx4 v[152:155], v7, s[44:47], s85 offen offset:1024 sc1
    v_and_b32 v16, 7, v2
    v_mul_u32_u24 v16, 1344, v16
    v_lshrrev_b32 v17, 4, v2
    v_lshl_add_u32 v16, v17, 4, v16
    s_mul_i32 s85, s3, 320
    s_add_u32 s85, s85, 143360
    v_add_u32 v35, s85, v16
    s_mov_b64 exec, 1
    v_mov_b32 v14, 1
    ds_add_u32 v13, v14 offset:28
    s_mov_b64 exec, -1
    s_mov_b32 s89, 1048576
L_lw_47:
    ds_read_b32 v14, v13 offset:40
    s_waitcnt lgkmcnt(0)
    v_readfirstlane_b32 s88, v14
    s_nop 0
    s_cmp_ge_u32 s88, 8
    s_cbranch_scc1 L_lwd_48
    s_sub_u32 s89, s89, 1
    s_cbranch_scc0 L_lw_47
L_lwd_48:
    ds_read_b128 v[120:123], v35 offset:0
    ds_read_b128 v[124:127], v35 offset:64
    ds_read_b128 v[128:131], v35 offset:128
    ds_read_b128 v[132:135], v35 offset:192
    ds_read_b128 v[136:139], v35 offset:256
    s_waitcnt vmcnt(19)
    ds_read_b64_tr_b16 v[40:41], v9 offset:0
    ds_read_b64_tr_b16 v[42:43], v9 offset:512
    ds_read_b64_tr_b16 v[44:45], v9 offset:32
    ds_read_b64_tr_b16 v[46:47], v9 offset:544
    ds_read_b64_tr_b16 v[48:49], v9 offset:64
    ds_read_b64_tr_b16 v[50:51], v9 offset:576
    ds_read_b64_tr_b16 v[52:53], v9 offset:96
    ds_read_b64_tr_b16 v[54:55], v9 offset:608
    s_waitcnt lgkmcnt(0)
    s_waitcnt vmcnt(15)
    ds_read_b64_tr_b16 v[56:57], v9 offset:4096
    ds_read_b64_tr_b16 v[58:59], v9 offset:4608
    ds_read_b64_tr_b16 v[60:61], v9 offset:4128
    ds_read_b64_tr_b16 v[62:63], v9 offset:4640
    ds_read_b64_tr_b16 v[64:65], v9 offset:4160
    ds_read_b64_tr_b16 v[66:67], v9 offset:4672
    ds_read_b64_tr_b16 v[68:69], v9 offset:4192
    ds_read_b64_tr_b16 v[70:71], v9 offset:4704
    s_waitcnt lgkmcnt(0)
    s_waitcnt vmcnt(11)
    ds_read_b64_tr_b16 v[72:73], v9 offset:8192
    ds_read_b64_tr_b16 v[74:75], v9 offset:8704
    ds_read_b64_tr_b16 v[76:77], v9 offset:8224
    ds_read_b64_tr_b16 v[78:79], v9 offset:8736
    ds_read_b64_tr_b16 v[80:81], v9 offset:8256
    ds_read_b64_tr_b16 v[82:83], v9 offset:8768
    ds_read_b64_tr_b16 v[84:85], v9 offset:8288
    ds_read_b64_tr_b16 v[86:87], v9 offset:8800
    s_waitcnt lgkmcnt(0)
    s_waitcnt vmcnt(7)
    ds_read_b64_tr_b16 v[88:89], v9 offset:12288
    ds_read_b64_tr_b16 v[90:91], v9 offset:12800
    ds_read_b64_tr_b16 v[92:93], v9 offset:12320
    ds_read_b64_tr_b16 v[94:95], v9 offset:12832
    ds_read_b64_tr_b16 v[96:97], v9 offset:12352
    ds_read_b64_tr_b16 v[98:99], v9 offset:12864
    ds_read_b64_tr_b16 v[100:101], v9 offset:12384
    ds_read_b64_tr_b16 v[102:103], v9 offset:12896
    s_waitcnt lgkmcnt(0)
    s_waitcnt vmcnt(3)
    ds_read_b64_tr_b16 v[104:105], v9 offset:16384
    ds_read_b64_tr_b16 v[106:107], v9 offset:16896
    ds_read_b64_tr_b16 v[108:109], v9 offset:16416
    ds_read_b64_tr_b16 v[110:111], v9 offset:16928
    ds_read_b64_tr_b16 v[112:113], v9 offset:16448
    ds_read_b64_tr_b16 v[114:115], v9 offset:16960
    ds_read_b64_tr_b16 v[116:117], v9 offset:16480
    ds_read_b64_tr_b16 v[118:119], v9 offset:16992
    s_waitcnt lgkmcnt(0)
    v_readfirstlane_b32 s94, v167
    s_nop 0
    s_mul_i32 s94, s94, 1664525
    s_add_u32 s94, s94, 1013904223
    s_waitcnt vmcnt(0)
    v_mfma_f32_16x16x32_bf16 v[16:19], v[40:43], v[120:123], 0
    v_mfma_f32_16x16x32_bf16 v[20:23], v[44:47], v[120:123], 0
    v_mfma_f32_16x16x32_bf16 v[16:19], v[56:59], v[124:127], v[16:19]
    v_mfma_f32_16x16x32_bf16 v[20:23], v[60:63], v[124:127], v[20:23]
    v_mfma_f32_16x16x32_bf16 v[16:19], v[72:75], v[128:131], v[16:19]
    v_mfma_f32_16x16x32_bf16 v[20:23], v[76:79], v[128:131], v[20:23]
    v_mfma_f32_16x16x32_bf16 v[16:19], v[88:91], v[132:135], v[16:19]
    v_mfma_f32_16x16x32_bf16 v[20:23], v[92:95], v[132:135], v[20:23]
    v_mfma_f32_16x16x32_bf16 v[16:19], v[104:107], v[136:139], v[16:19]
    v_mfma_f32_16x16x32_bf16 v[20:23], v[108:111], v[136:139], v[20:23]
    v_mfma_f32_16x16x32_bf16 v[24:27], v[48:51], v[120:123], 0
    v_mfma_f32_16x16x32_bf16 v[28:31], v[52:55], v[120:123], 0
    v_mfma_f32_16x16x32_bf16 v[24:27], v[64:67], v[124:127], v[24:27]
    v_mfma_f32_16x16x32_bf16 v[28:31], v[68:71], v[124:127], v[28:31]
    v_mfma_f32_16x16x32_bf16 v[24:27], v[80:83], v[128:131], v[24:27]
    v_mfma_f32_16x16x32_bf16 v[28:31], v[84:87], v[128:131], v[28:31]
    v_mfma_f32_16x16x32_bf16 v[24:27], v[96:99], v[132:135], v[24:27]
    v_mfma_f32_16x16x32_bf16 v[28:31], v[100:103], v[132:135], v[28:31]
    ds_write_b128 v10, v[16:19] offset:0
    v_mfma_f32_16x16x32_bf16 v[24:27], v[112:115], v[136:139], v[24:27]
    v_mfma_f32_16x16x32_bf16 v[28:31], v[116:119], v[136:139], v[28:31]
    ds_write_b128 v10, v[20:23] offset:1024
    s_nop 5
    ds_write_b128 v10, v[24:27] offset:2048
    ds_write_b128 v10, v[28:31] offset:3072
    s_mov_b64 exec, 1
    v_mov_b32 v14, 1
    ds_add_rtn_u32 v14, v13, v14 offset:0
    s_mov_b64 exec, -1
    ds_read_b128 v[40:43], v11 offset:0
    ds_read_b128 v[56:59], v11 offset:2048
    ds_read_b128 v[44:47], v11 offset:20480
    ds_read_b128 v[60:63], v11 offset:22528
    ds_read_b128 v[48:51], v11 offset:40960
    ds_read_b128 v[64:67], v11 offset:43008
    ds_read_b128 v[52:55], v11 offset:61440
    ds_read_b128 v[68:71], v11 offset:63488
    s_waitcnt lgkmcnt(8)
    v_readfirstlane_b32 s88, v14
    s_nop 0
    s_cmp_lg_u32 s88, 3
    s_cbranch_scc1 L_ctrl_end
    v_and_b32 v22, 7, v2
    v_lshl_add_u32 v23, v22, 3, v13
    ds_read_b64 v[36:37], v23 offset:64
    s_waitcnt lgkmcnt(0)
    v_pk_add_f32 v[40:41], v[40:41], v[44:45]
    v_pk_add_f32 v[42:43], v[42:43], v[46:47]
    v_pk_add_f32 v[48:49], v[48:49], v[52:53]
    v_pk_add_f32 v[50:51], v[50:51], v[54:55]
    v_pk_add_f32 v[40:41], v[40:41], v[48:49]
    v_pk_add_f32 v[42:43], v[42:43], v[50:51]
    v_pk_add_f32 v[56:57], v[56:57], v[60:61]
    v_pk_add_f32 v[58:59], v[58:59], v[62:63]
    v_pk_add_f32 v[64:65], v[64:65], v[68:69]
    v_pk_add_f32 v[66:67], v[66:67], v[70:71]
    v_pk_add_f32 v[56:57], v[56:57], v[64:65]
    v_pk_add_f32 v[58:59], v[58:59], v[66:67]
    v_cvt_pk_bf16_f32 v24, v40, v41
    v_cvt_pk_bf16_f32 v25, v42, v43
    v_cvt_pk_bf16_f32 v26, v56, v57
    v_cvt_pk_bf16_f32 v27, v58, v59
    v_lshlrev_b32 v56, 16, v26
    v_and_b32 v57, s84, v26
    v_lshlrev_b32 v58, 16, v27
    v_and_b32 v59, s84, v27
    v_pk_add_f32 v[56:57], v[56:57], 1.0 op_sel_hi:[1,0]
    v_pk_add_f32 v[58:59], v[58:59], 1.0 op_sel_hi:[1,0]
    v_cvt_pk_bf16_f32 v56, 0, v56
    v_cvt_pk_bf16_f32 v57, 0, v57
    v_cvt_pk_bf16_f32 v58, 0, v58
    v_cvt_pk_bf16_f32 v59, 0, v59
    v_lshlrev_b32 v40, 16, v24
    v_and_b32 v41, s84, v24
    v_lshlrev_b32 v42, 16, v25
    v_and_b32 v43, s84, v25
    v_lshlrev_b32 v44, 16, v150
    v_and_b32 v45, s84, v150
    v_lshlrev_b32 v46, 16, v151
    v_and_b32 v47, s84, v151
    v_sub_f32 v44, v44, v36
    v_sub_f32 v45, v45, v36
    v_sub_f32 v46, v46, v36
    v_sub_f32 v47, v47, v36
    v_cvt_pk_bf16_f32 v44, 0, v44
    v_cvt_pk_bf16_f32 v45, 0, v45
    v_cvt_pk_bf16_f32 v46, 0, v46
    v_cvt_pk_bf16_f32 v47, 0, v47
    v_mul_f32 v44, v44, v37
    v_mul_f32 v45, v45, v37
    v_mul_f32 v46, v46, v37
    v_mul_f32 v47, v47, v37
    v_cvt_pk_bf16_f32 v44, 0, v44
    v_cvt_pk_bf16_f32 v45, 0, v45
    v_cvt_pk_bf16_f32 v46, 0, v46
    v_cvt_pk_bf16_f32 v47, 0, v47
    v_pk_mul_f32 v[44:45], v[44:45], v[56:57]
    v_pk_mul_f32 v[46:47], v[46:47], v[58:59]
    v_cvt_pk_bf16_f32 v44, 0, v44
    v_cvt_pk_bf16_f32 v45, 0, v45
    v_cvt_pk_bf16_f32 v46, 0, v46
    v_cvt_pk_bf16_f32 v47, 0, v47
    v_pk_add_f32 v[44:45], v[44:45], v[40:41]
    v_pk_add_f32 v[46:47], v[46:47], v[42:43]
    v_cvt_pk_bf16_f32 v28, v44, v45
    v_cvt_pk_bf16_f32 v30, v46, v47
    v_mov_b32 v29, s94
    v_mov_b32 v31, s94
    v_lshlrev_b32 v22, 4, v22
    v_lshl_add_u32 v22, v8, 4, v22
    s_lshl_b32 s85, s8, 10
    s_add_u32 s85, s85, 4096
    buffer_store_dwordx4 v[28:31], v22, s[44:47], s85 offen sc1
    s_branch L_ctrl_end
L_role_q:
    s_lshl_b32 s9, s8, 7
    s_add_u32 s48, s22, s9
    s_addc_u32 s49, s23, 0
    s_add_u32 s50, s48, 64
    s_addc_u32 s51, s49, 0
    s_movk_i32 s52, 8192
    s_mov_b32 s89, 1048576
L_lw_49:
    ds_read_b32 v14, v13 offset:44
    s_waitcnt lgkmcnt(0)
    v_readfirstlane_b32 s88, v14
    s_nop 0
    s_cmp_ge_u32 s88, 1
    s_cbranch_scc1 L_lwd_50
    s_sleep 2
    s_sub_u32 s89, s89, 1
    s_cbranch_scc0 L_lw_49
L_lwd_50:
    v_lshrrev_b32 v16, 3, v2
    s_mul_i32 s85, s3, 160
    v_add_u32 v16, s85, v16
    v_mul_lo_u32 v16, s52, v16
    v_and_b32 v17, 3, v2
    v_lshl_add_u32 v16, v17, 4, v16
    v_mov_b32 v17, 0
    v_mov_b32 v18, s48
    v_mov_b32 v19, s49
    v_mov_b32 v20, s50
    v_mov_b32 v21, s51
    v_and_b32 v22, 4, v2
    v_cmp_ne_u32 vcc, 0, v22
    s_nop 1
    v_cndmask_b32 v18, v18, v20, vcc
    v_cndmask_b32 v19, v19, v21, vcc
    v_lshl_add_u64 v[4:5], v[16:17], 0, v[18:19]
    s_lshl_b32 s54, s52, 3
    s_mov_b32 s55, 0
    s_add_u32 m0, s87, 0
    s_nop 0
    global_load_lds_dwordx4 v[4:5], off
    v_lshl_add_u64 v[4:5], v[4:5], 0, s[54:55]
    s_add_u32 m0, s87, 1024
    s_nop 0
    global_load_lds_dwordx4 v[4:5], off
    v_lshl_add_u64 v[4:5], v[4:5], 0, s[54:55]
    s_add_u32 m0, s87, 2048
    s_nop 0
    global_load_lds_dwordx4 v[4:5], off
    v_lshl_add_u64 v[4:5], v[4:5], 0, s[54:55]
    s_add_u32 m0, s87, 3072
    s_nop 0
    global_load_lds_dwordx4 v[4:5], off
    v_lshl_add_u64 v[4:5], v[4:5], 0, s[54:55]
    s_add_u32 m0, s87, 4096
    s_nop 0
    global_load_lds_dwordx4 v[4:5], off
    v_lshl_add_u64 v[4:5], v[4:5], 0, s[54:55]
    s_add_u32 m0, s87, 5120
    s_nop 0
    global_load_lds_dwordx4 v[4:5], off
    v_lshl_add_u64 v[4:5], v[4:5], 0, s[54:55]
    s_add_u32 m0, s87, 6144
    s_nop 0
    global_load_lds_dwordx4 v[4:5], off
    v_lshl_add_u64 v[4:5], v[4:5], 0, s[54:55]
    s_add_u32 m0, s87, 7168
    s_nop 0
    global_load_lds_dwordx4 v[4:5], off
    v_lshl_add_u64 v[4:5], v[4:5], 0, s[54:55]
    s_add_u32 m0, s87, 8192
    s_nop 0
    global_load_lds_dwordx4 v[4:5], off
    v_lshl_add_u64 v[4:5], v[4:5], 0, s[54:55]
    s_add_u32 m0, s87, 9216
    s_nop 0
    global_load_lds_dwordx4 v[4:5], off
    v_lshl_add_u64 v[4:5], v[4:5], 0, s[54:55]
    s_add_u32 m0, s87, 10240
    s_nop 0
    global_load_lds_dwordx4 v[4:5], off
    v_lshl_add_u64 v[4:5], v[4:5], 0, s[54:55]
    s_add_u32 m0, s87, 11264
    s_nop 0
    global_load_lds_dwordx4 v[4:5], off
    v_lshl_add_u64 v[4:5], v[4:5], 0, s[54:55]
    s_add_u32 m0, s87, 12288
    s_nop 0
    global_load_lds_dwordx4 v[4:5], off
    v_lshl_add_u64 v[4:5], v[4:5], 0, s[54:55]
    s_add_u32 m0, s87, 13312
    s_nop 0
    global_load_lds_dwordx4 v[4:5], off
    v_lshl_add_u64 v[4:5], v[4:5], 0, s[54:55]
    s_add_u32 m0, s87, 14336
    s_nop 0
    global_load_lds_dwordx4 v[4:5], off
    v_lshl_add_u64 v[4:5], v[4:5], 0, s[54:55]
    s_add_u32 m0, s87, 15360
    s_nop 0
    global_load_lds_dwordx4 v[4:5], off
    v_lshl_add_u64 v[4:5], v[4:5], 0, s[54:55]
    s_add_u32 m0, s87, 16384
    s_nop 0
    global_load_lds_dwordx4 v[4:5], off
    v_lshl_add_u64 v[4:5], v[4:5], 0, s[54:55]
    s_add_u32 m0, s87, 17408
    s_nop 0
    global_load_lds_dwordx4 v[4:5], off
    v_lshl_add_u64 v[4:5], v[4:5], 0, s[54:55]
    s_add_u32 m0, s87, 18432
    s_nop 0
    global_load_lds_dwordx4 v[4:5], off
    v_lshl_add_u64 v[4:5], v[4:5], 0, s[54:55]
    s_add_u32 m0, s87, 19456
    s_nop 0
    global_load_lds_dwordx4 v[4:5], off
    s_and_b32 s85, s8, 1
    s_lshl_b32 s85, s85, 2
    s_add_u32 s85, s85, s3
    s_lshl_b32 s85, s85, 5
    s_lshr_b32 s86, s8, 1
    s_add_u32 s85, s85, s86
    s_mul_i32 s85, s85, 2560
    s_add_u32 s85, s85, 327680
    v_mov_b32 v152, -1
    v_mov_b32 v153, -1
    v_mov_b32 v154, -1
    v_mov_b32 v155, -1
    v_lshlrev_b32 v19, 3, v2
    buffer_store_dwordx4 v[152:155], v7, s[44:47], s85 offen sc1
    buffer_store_dwordx4 v[152:155], v7, s[44:47], s85 offen offset:1024 sc1
    buffer_store_dwordx2 v[152:153], v19, s[44:47], s85 offen offset:2048 sc1
    s_mov_b64 exec, 1
    v_mov_b32 v14, 1
    ds_add_u32 v13, v14 offset:28
    s_mov_b64 exec, -1
    s_waitcnt vmcnt(0)
    v_readfirstlane_b32 s94, v167
    s_nop 0
    s_mul_i32 s94, s94, 1664525
    s_add_u32 s94, s94, 1013904223
    ds_read_b64_tr_b16 v[40:41], v9 offset:0
    ds_read_b64_tr_b16 v[42:43], v9 offset:512
    ds_read_b64_tr_b16 v[44:45], v9 offset:32
    ds_read_b64_tr_b16 v[46:47], v9 offset:544
    ds_read_b64_tr_b16 v[48:49], v9 offset:64
    ds_read_b64_tr_b16 v[50:51], v9 offset:576
    ds_read_b64_tr_b16 v[52:53], v9 offset:96
    ds_read_b64_tr_b16 v[54:55], v9 offset:608
    s_waitcnt lgkmcnt(0)
    ds_read_b64_tr_b16 v[56:57], v9 offset:4096
    ds_read_b64_tr_b16 v[58:59], v9 offset:4608
    ds_read_b64_tr_b16 v[60:61], v9 offset:4128
    ds_read_b64_tr_b16 v[62:63], v9 offset:4640
    ds_read_b64_tr_b16 v[64:65], v9 offset:4160
    ds_read_b64_tr_b16 v[66:67], v9 offset:4672
    ds_read_b64_tr_b16 v[68:69], v9 offset:4192
    ds_read_b64_tr_b16 v[70:71], v9 offset:4704
    s_waitcnt lgkmcnt(0)
    ds_read_b64_tr_b16 v[72:73], v9 offset:8192
    ds_read_b64_tr_b16 v[74:75], v9 offset:8704
    ds_read_b64_tr_b16 v[76:77], v9 offset:8224
    ds_read_b64_tr_b16 v[78:79], v9 offset:8736
    ds_read_b64_tr_b16 v[80:81], v9 offset:8256
    ds_read_b64_tr_b16 v[82:83], v9 offset:8768
    ds_read_b64_tr_b16 v[84:85], v9 offset:8288
    ds_read_b64_tr_b16 v[86:87], v9 offset:8800
    s_waitcnt lgkmcnt(0)
    ds_read_b64_tr_b16 v[88:89], v9 offset:12288
    ds_read_b64_tr_b16 v[90:91], v9 offset:12800
    ds_read_b64_tr_b16 v[92:93], v9 offset:12320
    ds_read_b64_tr_b16 v[94:95], v9 offset:12832
    ds_read_b64_tr_b16 v[96:97], v9 offset:12352
    ds_read_b64_tr_b16 v[98:99], v9 offset:12864
    ds_read_b64_tr_b16 v[100:101], v9 offset:12384
    ds_read_b64_tr_b16 v[102:103], v9 offset:12896
    s_waitcnt lgkmcnt(0)
    ds_read_b64_tr_b16 v[104:105], v9 offset:16384
    ds_read_b64_tr_b16 v[106:107], v9 offset:16896
    ds_read_b64_tr_b16 v[108:109], v9 offset:16416
    ds_read_b64_tr_b16 v[110:111], v9 offset:16928
    ds_read_b64_tr_b16 v[112:113], v9 offset:16448
    ds_read_b64_tr_b16 v[114:115], v9 offset:16960
    ds_read_b64_tr_b16 v[116:117], v9 offset:16480
    ds_read_b64_tr_b16 v[118:119], v9 offset:16992
    s_waitcnt lgkmcnt(0)
    s_mul_i32 s90, s3, 5120
    s_add_u32 s90, s90, 4096
    s_add_u32 s91, s90, 4096
    s_mov_b32 s89, 65536
L_h1_poll:
    buffer_load_dwordx4 v[120:123], v7, s[44:47], s90 offen offset:0 sc1
    buffer_load_dwordx4 v[124:127], v7, s[44:47], s90 offen offset:1024 sc1
    buffer_load_dwordx4 v[128:131], v7, s[44:47], s90 offen offset:2048 sc1
    buffer_load_dwordx4 v[132:135], v7, s[44:47], s90 offen offset:3072 sc1
    buffer_load_dwordx4 v[136:139], v7, s[44:47], s91 offen offset:0 sc1
    s_waitcnt vmcnt(0)
    v_xor_b32 v36, s94, v121
    v_xor_b32 v37, s94, v123
    v_or_b32 v38, v36, v37
    v_xor_b32 v36, s94, v125
    v_xor_b32 v37, s94, v127
    v_or3_b32 v38, v38, v36, v37
    v_xor_b32 v36, s94, v129
    v_xor_b32 v37, s94, v131
    v_or3_b32 v38, v38, v36, v37
    v_xor_b32 v36, s94, v133
    v_xor_b32 v37, s94, v135
    v_or3_b32 v38, v38, v36, v37
    v_xor_b32 v36, s94, v137
    v_xor_b32 v37, s94, v139
    v_or3_b32 v38, v38, v36, v37
    v_cmp_ne_u32 vcc, 0, v38
    s_cbranch_vccz L_h1_ok
    s_sleep 4
    s_sub_u32 s89, s89, 1
    s_cbranch_scc0 L_h1_poll
L_h1_ok:
    v_mov_b32_dpp v123, v122 row_ror:8 row_mask:0xf bank_mask:0xf
    v_mov_b32 v121, v122
    v_mov_b32_dpp v122, v120 row_ror:8 row_mask:0xf bank_mask:0xf
    v_mov_b32_dpp v127, v126 row_ror:8 row_mask:0xf bank_mask:0xf
    v_mov_b32 v125, v126
    v_mov_b32_dpp v126, v124 row_ror:8 row_mask:0xf bank_mask:0xf
    v_mov_b32_dpp v131, v130 row_ror:8 row_mask:0xf bank_mask:0xf
    v_mov_b32 v129, v130
    v_mov_b32_dpp v130, v128 row_ror:8 row_mask:0xf bank_mask:0xf
    v_mov_b32_dpp v135, v134 row_ror:8 row_mask:0xf bank_mask:0xf
    v_mov_b32 v133, v134
    v_mov_b32_dpp v134, v132 row_ror:8 row_mask:0xf bank_mask:0xf
    v_mov_b32_dpp v139, v138 row_ror:8 row_mask:0xf bank_mask:0xf
    v_mov_b32 v137, v138
    v_mov_b32_dpp v138, v136 row_ror:8 row_mask:0xf bank_mask:0xf
    v_mfma_f32_16x16x32_bf16 v[16:19], v[40:43], v[120:123], 0
    v_mfma_f32_16x16x32_bf16 v[20:23], v[44:47], v[120:123], 0
    v_mfma_f32_16x16x32_bf16 v[16:19], v[56:59], v[124:127], v[16:19]
    v_mfma_f32_16x16x32_bf16 v[20:23], v[60:63], v[124:127], v[20:23]
    v_mfma_f32_16x16x32_bf16 v[16:19], v[72:75], v[128:131], v[16:19]
    v_mfma_f32_16x16x32_bf16 v[20:23], v[76:79], v[128:131], v[20:23]
    v_mfma_f32_16x16x32_bf16 v[16:19], v[88:91], v[132:135], v[16:19]
    v_mfma_f32_16x16x32_bf16 v[20:23], v[92:95], v[132:135], v[20:23]
    v_mfma_f32_16x16x32_bf16 v[16:19], v[104:107], v[136:139], v[16:19]
    v_mfma_f32_16x16x32_bf16 v[20:23], v[108:111], v[136:139], v[20:23]
    v_mfma_f32_16x16x32_bf16 v[24:27], v[48:51], v[120:123], 0
    v_mfma_f32_16x16x32_bf16 v[28:31], v[52:55], v[120:123], 0
    v_mfma_f32_16x16x32_bf16 v[24:27], v[64:67], v[124:127], v[24:27]
    v_mfma_f32_16x16x32_bf16 v[28:31], v[68:71], v[124:127], v[28:31]
    v_mfma_f32_16x16x32_bf16 v[24:27], v[80:83], v[128:131], v[24:27]
    v_mfma_f32_16x16x32_bf16 v[28:31], v[84:87], v[128:131], v[28:31]
    v_mfma_f32_16x16x32_bf16 v[24:27], v[96:99], v[132:135], v[24:27]
    v_mfma_f32_16x16x32_bf16 v[28:31], v[100:103], v[132:135], v[28:31]
    ds_write_b128 v10, v[16:19] offset:0
    v_mfma_f32_16x16x32_bf16 v[24:27], v[112:115], v[136:139], v[24:27]
    v_mfma_f32_16x16x32_bf16 v[28:31], v[116:119], v[136:139], v[28:31]
    ds_write_b128 v10, v[20:23] offset:1024
    s_nop 5
    ds_write_b128 v10, v[24:27] offset:2048
    ds_write_b128 v10, v[28:31] offset:3072
    s_mov_b64 exec, 1
    v_mov_b32 v14, 1
    ds_add_rtn_u32 v14, v13, v14 offset:0
    s_mov_b64 exec, -1
    ds_read_b128 v[40:43], v11 offset:0
    ds_read_b128 v[56:59], v11 offset:2048
    ds_read_b128 v[44:47], v11 offset:20480
    ds_read_b128 v[60:63], v11 offset:22528
    ds_read_b128 v[48:51], v11 offset:40960
    ds_read_b128 v[64:67], v11 offset:43008
    ds_read_b128 v[52:55], v11 offset:61440
    ds_read_b128 v[68:71], v11 offset:63488
    s_waitcnt lgkmcnt(8)
    v_readfirstlane_b32 s88, v14
    s_nop 0
    s_cmp_lg_u32 s88, 3
    s_cbranch_scc1 L_ctrl_end
    v_and_b32 v22, 7, v2
    v_lshlrev_b32 v22, 14, v22
    v_lshl_add_u32 v22, v8, 1, v22
    s_lshl_b32 s85, s8, 8
    s_add_u32 s85, s85, 32768
    v_mov_b32 v29, s94
    v_mov_b32 v31, s94
    v_mov_b32 v33, s94
    v_mov_b32 v35, s94
    s_waitcnt lgkmcnt(0)
    v_pk_add_f32 v[40:41], v[40:41], v[44:45]
    v_pk_add_f32 v[42:43], v[42:43], v[46:47]
    v_pk_add_f32 v[48:49], v[48:49], v[52:53]
    v_pk_add_f32 v[50:51], v[50:51], v[54:55]
    v_pk_add_f32 v[40:41], v[40:41], v[48:49]
    v_pk_add_f32 v[42:43], v[42:43], v[50:51]
    v_pk_add_f32 v[56:57], v[56:57], v[60:61]
    v_pk_add_f32 v[58:59], v[58:59], v[62:63]
    v_pk_add_f32 v[64:65], v[64:65], v[68:69]
    v_pk_add_f32 v[66:67], v[66:67], v[70:71]
    v_pk_add_f32 v[56:57], v[56:57], v[64:65]
    v_pk_add_f32 v[58:59], v[58:59], v[66:67]
    v_cvt_pk_bf16_f32 v28, v40, v41
    v_cvt_pk_bf16_f32 v30, v42, v43
    v_cvt_pk_bf16_f32 v32, v56, v57
    v_cvt_pk_bf16_f32 v34, v58, v59
    buffer_store_dwordx4 v[28:31], v22, s[44:47], s85 offen sc1
    buffer_store_dwordx4 v[32:35], v22, s[44:47], s85 offen offset:128 sc1
    s_branch L_ctrl_end
L_role_ffn:
    s_lshl_b32 s9, s8, 6
    s_add_u32 s48, s28, s9
    s_addc_u32 s49, s29, 0
    s_add_u32 s50, s30, s9
    s_addc_u32 s51, s31, 0
    s_movk_i32 s52, 3456
    s_bitcmp1_b32 s8, 0
    s_cselect_b32 s53, 96, 0
    s_cselect_b32 s96, 4294441984, 0
    s_cselect_b32 s97, -1, 0
    s_cselect_b32 s98, 192, 0
    s_cselect_b32 s99, -128, 0
    s_cbranch_scc1 L_ffn_r
    s_movk_i32 s96, 27648
L_ffn_r:
    v_lshrrev_b32 v16, 3, v2
    s_mul_i32 s85, s3, 160
    s_add_u32 s85, s85, s53
    v_add_u32 v16, s85, v16
    v_mul_lo_u32 v16, s52, v16
    v_and_b32 v17, 3, v2
    v_lshl_add_u32 v16, v17, 4, v16
    v_mov_b32 v17, 0
    v_mov_b32 v18, s48
    v_mov_b32 v19, s49
    v_mov_b32 v20, s50
    v_mov_b32 v21, s51
    v_and_b32 v22, 4, v2
    v_cmp_ne_u32 vcc, 0, v22
    s_nop 1
    v_cndmask_b32 v18, v18, v20, vcc
    v_cndmask_b32 v19, v19, v21, vcc
    v_lshl_add_u64 v[4:5], v[16:17], 0, v[18:19]
    s_lshl_b32 s54, s52, 3
    s_mov_b32 s55, 0
    s_barrier
    s_barrier
    s_mov_b32 s89, 1048576
L_lw_51:
    ds_read_b32 v14, v13 offset:32
    s_waitcnt lgkmcnt(0)
    v_readfirstlane_b32 s88, v14
    s_nop 0
    s_cmp_ge_u32 s88, 5
    s_cbranch_scc1 L_lwd_52
    s_sub_u32 s89, s89, 1
    s_cbranch_scc0 L_lw_51
L_lwd_52:
    s_add_u32 m0, s87, 0
    s_nop 0
    global_load_lds_dwordx4 v[4:5], off
    v_lshl_add_u64 v[4:5], v[4:5], 0, s[54:55]
    s_add_u32 m0, s87, 1024
    s_nop 0
    global_load_lds_dwordx4 v[4:5], off
    v_lshl_add_u64 v[4:5], v[4:5], 0, s[54:55]
    s_add_u32 m0, s87, 2048
    s_nop 0
    global_load_lds_dwordx4 v[4:5], off
    v_lshl_add_u64 v[4:5], v[4:5], 0, s[54:55]
    s_add_u32 m0, s87, 3072
    s_nop 0
    global_load_lds_dwordx4 v[4:5], off
    v_lshl_add_u64 v[4:5], v[4:5], 0, s[54:55]
    s_add_u32 m0, s87, 4096
    s_nop 0
    global_load_lds_dwordx4 v[4:5], off
    v_lshl_add_u64 v[4:5], v[4:5], 0, s[54:55]
    s_add_u32 m0, s87, 5120
    s_nop 0
    global_load_lds_dwordx4 v[4:5], off
    v_lshl_add_u64 v[4:5], v[4:5], 0, s[54:55]
    s_add_u32 m0, s87, 6144
    s_nop 0
    global_load_lds_dwordx4 v[4:5], off
    v_lshl_add_u64 v[4:5], v[4:5], 0, s[54:55]
    s_add_u32 m0, s87, 7168
    s_nop 0
    global_load_lds_dwordx4 v[4:5], off
    v_lshl_add_u64 v[4:5], v[4:5], 0, s[96:97]
    s_add_u32 m0, s87, 8192
    s_nop 0
    global_load_lds_dwordx4 v[4:5], off
    v_lshl_add_u64 v[4:5], v[4:5], 0, s[54:55]
    s_add_u32 m0, s87, 9216
    s_nop 0
    global_load_lds_dwordx4 v[4:5], off
    v_lshl_add_u64 v[4:5], v[4:5], 0, s[54:55]
    s_add_u32 m0, s87, 10240
    s_nop 0
    global_load_lds_dwordx4 v[4:5], off
    v_lshl_add_u64 v[4:5], v[4:5], 0, s[54:55]
    s_add_u32 m0, s87, 11264
    s_nop 0
    global_load_lds_dwordx4 v[4:5], off
    v_lshl_add_u64 v[4:5], v[4:5], 0, s[54:55]
    s_add_u32 m0, s87, 12288
    s_nop 0
    global_load_lds_dwordx4 v[4:5], off
    v_lshl_add_u64 v[4:5], v[4:5], 0, s[54:55]
    s_add_u32 m0, s87, 13312
    s_nop 0
    global_load_lds_dwordx4 v[4:5], off
    v_lshl_add_u64 v[4:5], v[4:5], 0, s[54:55]
    s_add_u32 m0, s87, 14336
    s_nop 0
    global_load_lds_dwordx4 v[4:5], off
    v_lshl_add_u64 v[4:5], v[4:5], 0, s[54:55]
    s_add_u32 m0, s87, 15360
    s_nop 0
    global_load_lds_dwordx4 v[4:5], off
    v_lshl_add_u64 v[4:5], v[4:5], 0, s[54:55]
    s_add_u32 m0, s87, 16384
    s_nop 0
    global_load_lds_dwordx4 v[4:5], off
    v_lshl_add_u64 v[4:5], v[4:5], 0, s[54:55]
    s_add_u32 m0, s87, 17408
    s_nop 0
    global_load_lds_dwordx4 v[4:5], off
    v_lshl_add_u64 v[4:5], v[4:5], 0, s[54:55]
    s_add_u32 m0, s87, 18432
    s_nop 0
    global_load_lds_dwordx4 v[4:5], off
    v_lshl_add_u64 v[4:5], v[4:5], 0, s[54:55]
    s_add_u32 m0, s87, 19456
    s_nop 0
    global_load_lds_dwordx4 v[4:5], off
    s_waitcnt vmcnt(16)
    ds_read_b64_tr_b16 v[40:41], v9 offset:0
    ds_read_b64_tr_b16 v[42:43], v9 offset:512
    ds_read_b64_tr_b16 v[44:45], v9 offset:32
    ds_read_b64_tr_b16 v[46:47], v9 offset:544
    ds_read_b64_tr_b16 v[48:49], v9 offset:64
    ds_read_b64_tr_b16 v[50:51], v9 offset:576
    ds_read_b64_tr_b16 v[52:53], v9 offset:96
    ds_read_b64_tr_b16 v[54:55], v9 offset:608
    s_waitcnt lgkmcnt(0)
    s_waitcnt vmcnt(12)
    ds_read_b64_tr_b16 v[56:57], v9 offset:4096
    ds_read_b64_tr_b16 v[58:59], v9 offset:4608
    ds_read_b64_tr_b16 v[60:61], v9 offset:4128
    ds_read_b64_tr_b16 v[62:63], v9 offset:4640
    ds_read_b64_tr_b16 v[64:65], v9 offset:4160
    ds_read_b64_tr_b16 v[66:67], v9 offset:4672
    ds_read_b64_tr_b16 v[68:69], v9 offset:4192
    ds_read_b64_tr_b16 v[70:71], v9 offset:4704
    s_waitcnt lgkmcnt(0)
    s_waitcnt vmcnt(8)
    ds_read_b64_tr_b16 v[72:73], v9 offset:8192
    ds_read_b64_tr_b16 v[74:75], v9 offset:8704
    ds_read_b64_tr_b16 v[76:77], v9 offset:8224
    ds_read_b64_tr_b16 v[78:79], v9 offset:8736
    ds_read_b64_tr_b16 v[80:81], v9 offset:8256
    ds_read_b64_tr_b16 v[82:83], v9 offset:8768
    ds_read_b64_tr_b16 v[84:85], v9 offset:8288
    ds_read_b64_tr_b16 v[86:87], v9 offset:8800
    s_waitcnt lgkmcnt(0)
    s_waitcnt vmcnt(4)
    ds_read_b64_tr_b16 v[88:89], v9 offset:12288
    ds_read_b64_tr_b16 v[90:91], v9 offset:12800
    ds_read_b64_tr_b16 v[92:93], v9 offset:12320
    ds_read_b64_tr_b16 v[94:95], v9 offset:12832
    ds_read_b64_tr_b16 v[96:97], v9 offset:12352
    ds_read_b64_tr_b16 v[98:99], v9 offset:12864
    ds_read_b64_tr_b16 v[100:101], v9 offset:12384
    ds_read_b64_tr_b16 v[102:103], v9 offset:12896
    s_waitcnt lgkmcnt(0)
    s_waitcnt vmcnt(0)
    ds_read_b64_tr_b16 v[104:105], v9 offset:16384
    ds_read_b64_tr_b16 v[106:107], v9 offset:16896
    ds_read_b64_tr_b16 v[108:109], v9 offset:16416
    ds_read_b64_tr_b16 v[110:111], v9 offset:16928
    ds_read_b64_tr_b16 v[112:113], v9 offset:16448
    ds_read_b64_tr_b16 v[114:115], v9 offset:16960
    ds_read_b64_tr_b16 v[116:117], v9 offset:16480
    ds_read_b64_tr_b16 v[118:119], v9 offset:16992
    s_waitcnt lgkmcnt(0)
    s_mul_i32 s90, s3, 320
    s_add_u32 s90, s90, 163840
    v_lshrrev_b32 v33, 3, v2
    v_and_b32 v35, 7, v2
    v_mul_u32_u24 v6, 1280, v33
    v_and_b32 v34, 3, v35
    v_lshl_add_u32 v34, v34, 4, v6
    v_lshl_add_u32 v6, v35, 4, v6
    v_mul_u32_u24 v3, 400, v33
    v_lshl_add_u32 v3, v35, 4, v3
    s_add_u32 s85, s87, 8192
    v_add_u32 v3, s85, v3
    v_mul_u32_u24 v4, 400, v35
    v_lshrrev_b32 v33, 4, v2
    v_lshl_add_u32 v4, v33, 4, v4
    v_add_u32 v4, s85, v4
    v_mov_b32 v12, v4
    v_add_u32 v5, s99, v4
    v_add_u32 v4, s98, v4
    v_and_b32 v32, 7, v2
    v_lshlrev_b32 v32, 4, v32
    v_bfe_u32 v33, v2, 3, 1
    v_lshl_add_u32 v32, v33, 8, v32
    v_bfe_u32 v33, v2, 5, 1
    v_lshl_add_u32 v32, v33, 7, v32
    s_lshl_b32 s91, s8, 9
    s_add_u32 s91, s91, 188416
    s_waitcnt lgkmcnt(0)
    s_mov_b32 s89, 65536
L_h2_poll:
    buffer_load_dwordx4 v[140:143], v6, s[44:47], s90 offen sc1
    buffer_load_dwordx4 v[144:147], v6, s[44:47], s90 offen offset:128 sc1
    buffer_load_dwordx4 v[148:151], v34, s[44:47], s90 offen offset:256 sc1
    s_waitcnt vmcnt(0)
    v_max_u32 v38, v140, v141
    v_max3_u32 v38, v38, v142, v143
    v_max3_u32 v38, v38, v144, v145
    v_max3_u32 v38, v38, v146, v147
    v_max3_u32 v38, v38, v148, v149
    v_max3_u32 v38, v38, v150, v151
    v_cmp_eq_u32 vcc, -1, v38
    s_cbranch_vccz L_h2_ok
    s_mov_b64 exec, vcc
    s_sub_u32 s89, s89, 1
    s_cbranch_scc0 L_h2_poll
L_h2_ok:
    s_mov_b64 exec, -1
    ds_write_b128 v3, v[140:143] offset:0
    ds_write_b128 v3, v[144:147] offset:128
    ds_write_b128 v3, v[148:151] offset:256
    ds_read_b128 v[120:123], v4 offset:0
    ds_read_b128 v[124:127], v4 offset:64
    ds_read_b128 v[128:131], v5 offset:128
    ds_read_b128 v[132:135], v5 offset:192
    ds_read_b128 v[136:139], v5 offset:256
    s_waitcnt lgkmcnt(4)
    v_mfma_f32_16x16x32_bf16 v[16:19], v[40:43], v[120:123], 0
    v_mfma_f32_16x16x32_bf16 v[20:23], v[44:47], v[120:123], 0
    s_waitcnt lgkmcnt(3)
    v_mfma_f32_16x16x32_bf16 v[16:19], v[56:59], v[124:127], v[16:19]
    v_mfma_f32_16x16x32_bf16 v[20:23], v[60:63], v[124:127], v[20:23]
    s_waitcnt lgkmcnt(2)
    v_mfma_f32_16x16x32_bf16 v[16:19], v[72:75], v[128:131], v[16:19]
    v_mfma_f32_16x16x32_bf16 v[20:23], v[76:79], v[128:131], v[20:23]
    s_waitcnt lgkmcnt(1)
    v_mfma_f32_16x16x32_bf16 v[16:19], v[88:91], v[132:135], v[16:19]
    v_mfma_f32_16x16x32_bf16 v[20:23], v[92:95], v[132:135], v[20:23]
    s_waitcnt lgkmcnt(0)
    v_mfma_f32_16x16x32_bf16 v[16:19], v[104:107], v[136:139], v[16:19]
    v_mfma_f32_16x16x32_bf16 v[20:23], v[108:111], v[136:139], v[20:23]
    v_mfma_f32_16x16x32_bf16 v[24:27], v[48:51], v[120:123], 0
    v_mfma_f32_16x16x32_bf16 v[28:31], v[52:55], v[120:123], 0
    v_mfma_f32_16x16x32_bf16 v[24:27], v[64:67], v[124:127], v[24:27]
    v_mfma_f32_16x16x32_bf16 v[28:31], v[68:71], v[124:127], v[28:31]
    v_mfma_f32_16x16x32_bf16 v[24:27], v[80:83], v[128:131], v[24:27]
    v_mfma_f32_16x16x32_bf16 v[28:31], v[84:87], v[128:131], v[28:31]
    v_mfma_f32_16x16x32_bf16 v[24:27], v[96:99], v[132:135], v[24:27]
    v_mfma_f32_16x16x32_bf16 v[28:31], v[100:103], v[132:135], v[28:31]
    ds_write_b128 v10, v[16:19] offset:0
    v_mfma_f32_16x16x32_bf16 v[24:27], v[112:115], v[136:139], v[24:27]
    v_mfma_f32_16x16x32_bf16 v[28:31], v[116:119], v[136:139], v[28:31]
    ds_write_b128 v10, v[20:23] offset:1024
    s_nop 5
    ds_write_b128 v10, v[24:27] offset:2048
    ds_write_b128 v10, v[28:31] offset:3072
    s_mov_b64 exec, 1
    v_mov_b32 v14, 1
    ds_add_rtn_u32 v14, v13, v14 offset:0
    s_mov_b64 exec, -1
    ds_read_b128 v[40:43], v11 offset:0
    ds_read_b128 v[56:59], v11 offset:2048
    ds_read_b128 v[44:47], v11 offset:20480
    ds_read_b128 v[60:63], v11 offset:22528
    ds_read_b128 v[48:51], v11 offset:40960
    ds_read_b128 v[64:67], v11 offset:43008
    ds_read_b128 v[52:55], v11 offset:61440
    ds_read_b128 v[68:71], v11 offset:63488
    s_waitcnt lgkmcnt(8)
    v_readfirstlane_b32 s88, v14
    s_nop 0
    s_cmp_lg_u32 s88, 3
    s_cbranch_scc1 L_ctrl_end
    s_waitcnt lgkmcnt(0)
    v_pk_add_f32 v[40:41], v[40:41], v[44:45]
    v_pk_add_f32 v[42:43], v[42:43], v[46:47]
    v_pk_add_f32 v[48:49], v[48:49], v[52:53]
    v_pk_add_f32 v[50:51], v[50:51], v[54:55]
    v_pk_add_f32 v[40:41], v[40:41], v[48:49]
    v_pk_add_f32 v[42:43], v[42:43], v[50:51]
    v_pk_add_f32 v[56:57], v[56:57], v[60:61]
    v_pk_add_f32 v[58:59], v[58:59], v[62:63]
    v_pk_add_f32 v[64:65], v[64:65], v[68:69]
    v_pk_add_f32 v[66:67], v[66:67], v[70:71]
    v_pk_add_f32 v[56:57], v[56:57], v[64:65]
    v_pk_add_f32 v[58:59], v[58:59], v[66:67]
    v_cvt_pk_bf16_f32 v40, 0, v40
    v_cvt_pk_bf16_f32 v41, 0, v41
    v_cvt_pk_bf16_f32 v42, 0, v42
    v_cvt_pk_bf16_f32 v43, 0, v43
    v_cvt_pk_bf16_f32 v56, 0, v56
    v_cvt_pk_bf16_f32 v57, 0, v57
    v_cvt_pk_bf16_f32 v58, 0, v58
    v_cvt_pk_bf16_f32 v59, 0, v59
    v_cmp_lt_f32 s[64:65], 0, v40
    v_cmp_lt_f32 s[66:67], 0, v41
    v_cmp_lt_f32 s[68:69], 0, v42
    v_cmp_lt_f32 s[70:71], 0, v43
    v_cndmask_b32 v20, 0, 1.0, s[64:65]
    v_cndmask_b32 v21, 0, 1.0, s[66:67]
    v_cndmask_b32 v22, 0, 1.0, s[68:69]
    v_cndmask_b32 v23, 0, 1.0, s[70:71]
    v_pk_mul_f32 v[40:41], v[40:41], v[20:21]
    v_pk_mul_f32 v[42:43], v[42:43], v[22:23]
    v_pk_mul_f32 v[40:41], v[40:41], v[56:57]
    v_pk_mul_f32 v[42:43], v[42:43], v[58:59]
    v_cvt_pk_bf16_f32 v28, v40, v41
    v_cvt_pk_bf16_f32 v29, v42, v43
    v_min_u32 v30, -2, v28
    v_min_u32 v31, -2, v29
    v_min_u32 v28, -2, v28
    v_min_u32 v29, -2, v29
    s_nop 0
    v_permlane16_swap_b32 v28, v30
    v_permlane16_swap_b32 v29, v31
    s_mov_b32 exec_lo, 0xffff
    s_mov_b32 exec_hi, 0xffff
    buffer_store_dwordx4 v[28:31], v32, s[44:47], s91 offen sc1
    s_mov_b64 exec, -1
    s_branch L_ctrl_end
L_role_down:
    s_mov_b32 s72, s32
    s_mov_b32 s73, s33
    s_mov_b32 s74, 2211840
    s_mov_b32 s75, 0x20000
    s_mov_b32 s80, s38
    s_mov_b32 s81, s39
    s_mov_b32 s82, 10240
    s_mov_b32 s83, 0x20000
    s_add_u32 s76, s42, 188416
    s_addc_u32 s77, s43, 0
    s_mov_b32 s78, 27648
    s_mov_b32 s79, 0x20000
    v_lshrrev_b32 v16, 1, v2
    v_mul_u32_u24 v4, 1280, v16
    v_and_b32 v16, 1, v2
    v_lshl_add_u32 v4, v16, 4, v4
    s_mul_i32 s85, s3, 573440
    s_lshl_b32 s9, s8, 5
    s_add_u32 s85, s85, s9
    s_mul_i32 s87, s3, 14336
    s_and_b32 s48, s8, 3
    s_lshl_b32 s48, s48, 11
    s_add_u32 s49, s48, 1024
    s_cmp_ge_u32 s49, 7168
    s_cselect_b32 s49, 0, s49
    s_add_u32 s50, s49, 1024
    s_cmp_ge_u32 s50, 7168
    s_cselect_b32 s50, 0, s50
    s_add_u32 s51, s50, 1024
    s_cmp_ge_u32 s51, 7168
    s_cselect_b32 s51, 0, s51
    s_add_u32 s52, s51, 1024
    s_cmp_ge_u32 s52, 7168
    s_cselect_b32 s52, 0, s52
    s_add_u32 s53, s52, 1024
    s_cmp_ge_u32 s53, 7168
    s_cselect_b32 s53, 0, s53
    s_add_u32 s54, s53, 1024
    s_cmp_ge_u32 s54, 7168
    s_cselect_b32 s54, 0, s54
    s_barrier
    s_barrier
    s_mov_b32 s89, 1048576
L_lw_53:
    ds_read_b32 v14, v13 offset:32
    s_waitcnt lgkmcnt(0)
    v_readfirstlane_b32 s88, v14
    s_nop 0
    s_cmp_ge_u32 s88, 5
    s_cbranch_scc1 L_lwd_54
    s_sub_u32 s89, s89, 1
    s_cbranch_scc0 L_lw_53
L_lwd_54:
    s_mul_i32 s55, s48, 80
    s_add_u32 s55, s55, s85
    s_add_u32 m0, s87, 0
    s_nop 0
    buffer_load_dwordx4 v4, s[72:75], s55 offen  lds
    s_add_u32 s55, s55, 40960
    s_add_u32 m0, s87, 1024
    s_nop 0
    buffer_load_dwordx4 v4, s[72:75], s55 offen  lds
    s_mul_i32 s55, s49, 80
    s_add_u32 s55, s55, s85
    s_add_u32 m0, s87, 2048
    s_nop 0
    buffer_load_dwordx4 v4, s[72:75], s55 offen  lds
    s_add_u32 s55, s55, 40960
    s_add_u32 m0, s87, 3072
    s_nop 0
    buffer_load_dwordx4 v4, s[72:75], s55 offen  lds
    s_mul_i32 s55, s50, 80
    s_add_u32 s55, s55, s85
    s_add_u32 m0, s87, 4096
    s_nop 0
    buffer_load_dwordx4 v4, s[72:75], s55 offen  lds
    s_add_u32 s55, s55, 40960
    s_add_u32 m0, s87, 5120
    s_nop 0
    buffer_load_dwordx4 v4, s[72:75], s55 offen  lds
    s_mul_i32 s55, s51, 80
    s_add_u32 s55, s55, s85
    s_add_u32 m0, s87, 6144
    s_nop 0
    buffer_load_dwordx4 v4, s[72:75], s55 offen  lds
    s_add_u32 s55, s55, 40960
    s_add_u32 m0, s87, 7168
    s_nop 0
    buffer_load_dwordx4 v4, s[72:75], s55 offen  lds
    s_mul_i32 s55, s52, 80
    s_add_u32 s55, s55, s85
    s_add_u32 m0, s87, 8192
    s_nop 0
    buffer_load_dwordx4 v4, s[72:75], s55 offen  lds
    s_add_u32 s55, s55, 40960
    s_add_u32 m0, s87, 9216
    s_nop 0
    buffer_load_dwordx4 v4, s[72:75], s55 offen  lds
    s_mul_i32 s55, s53, 80
    s_add_u32 s55, s55, s85
    s_add_u32 m0, s87, 10240
    s_nop 0
    buffer_load_dwordx4 v4, s[72:75], s55 offen  lds
    s_add_u32 s55, s55, 40960
    s_add_u32 m0, s87, 11264
    s_nop 0
    buffer_load_dwordx4 v4, s[72:75], s55 offen  lds
    s_mul_i32 s55, s54, 80
    s_add_u32 s55, s55, s85
    s_add_u32 m0, s87, 12288
    s_nop 0
    buffer_load_dwordx4 v4, s[72:75], s55 offen  lds
    s_add_u32 s55, s55, 40960
    s_add_u32 m0, s87, 13312
    s_nop 0
    buffer_load_dwordx4 v4, s[72:75], s55 offen  lds
    v_lshrrev_b32 v16, 4, v2
    v_bfe_u32 v17, v2, 2, 2
    v_lshl_add_u32 v19, v16, 3, v17
    v_lshlrev_b32 v9, 5, v19
    v_bfe_u32 v17, v2, 1, 1
    v_lshl_add_u32 v9, v17, 10, v9
    v_and_b32 v17, 1, v2
    v_lshl_add_u32 v9, v17, 3, v9
    v_add_u32 v9, s87, v9
    v_add_u32 v10, s87, v7
    v_and_b32 v17, 7, v2
    v_bfe_u32 v18, v2, 3, 1
    v_lshlrev_b32 v3, 7, v16
    v_lshl_add_u32 v3, v17, 4, v3
    v_lshl_add_u32 v3, v18, 9, v3
    s_mul_i32 s86, s3, 7168
    v_add_u32 v3, s86, v3
    v_and_b32 v16, 1, v16
    v_lshlrev_b32 v11, 8, v16
    v_lshl_add_u32 v11, v17, 4, v11
    v_lshl_add_u32 v11, v18, 10, v11
    v_lshlrev_b32 v8, 4, v18
    v_lshl_add_u32 v8, v16, 3, v8
    v_mul_u32_u24 v5, 5120, v17
    v_add_u32 v5, v5, v8
    v_mul_u32_u24 v6, 1280, v17
    v_add_u32 v6, v6, v8
    s_add_u32 s90, s9, 220928
    s_add_u32 s91, s9, 176128
    s_movk_i32 s92, 4096
    s_waitcnt vmcnt(12)
    ds_read_b64_tr_b16 v[40:41], v9 offset:0
    ds_read_b64_tr_b16 v[42:43], v9 offset:128
    ds_read_b64_tr_b16 v[44:45], v9 offset:16
    ds_read_b64_tr_b16 v[46:47], v9 offset:144
    s_waitcnt vmcnt(10)
    ds_read_b64_tr_b16 v[48:49], v9 offset:2048
    ds_read_b64_tr_b16 v[50:51], v9 offset:2176
    ds_read_b64_tr_b16 v[52:53], v9 offset:2064
    ds_read_b64_tr_b16 v[54:55], v9 offset:2192
    s_waitcnt lgkmcnt(0)
    s_waitcnt vmcnt(8)
    ds_read_b64_tr_b16 v[56:57], v9 offset:4096
    ds_read_b64_tr_b16 v[58:59], v9 offset:4224
    ds_read_b64_tr_b16 v[60:61], v9 offset:4112
    ds_read_b64_tr_b16 v[62:63], v9 offset:4240
    s_waitcnt vmcnt(6)
    ds_read_b64_tr_b16 v[64:65], v9 offset:6144
    ds_read_b64_tr_b16 v[66:67], v9 offset:6272
    ds_read_b64_tr_b16 v[68:69], v9 offset:6160
    ds_read_b64_tr_b16 v[70:71], v9 offset:6288
    s_waitcnt lgkmcnt(0)
    s_waitcnt vmcnt(4)
    ds_read_b64_tr_b16 v[72:73], v9 offset:8192
    ds_read_b64_tr_b16 v[74:75], v9 offset:8320
    ds_read_b64_tr_b16 v[76:77], v9 offset:8208
    ds_read_b64_tr_b16 v[78:79], v9 offset:8336
    s_waitcnt vmcnt(2)
    ds_read_b64_tr_b16 v[80:81], v9 offset:10240
    ds_read_b64_tr_b16 v[82:83], v9 offset:10368
    ds_read_b64_tr_b16 v[84:85], v9 offset:10256
    ds_read_b64_tr_b16 v[86:87], v9 offset:10384
    s_waitcnt lgkmcnt(0)
    s_waitcnt vmcnt(0)
    ds_read_b64_tr_b16 v[88:89], v9 offset:12288
    ds_read_b64_tr_b16 v[90:91], v9 offset:12416
    ds_read_b64_tr_b16 v[92:93], v9 offset:12304
    ds_read_b64_tr_b16 v[94:95], v9 offset:12432
    v_readfirstlane_b32 s94, v167
    s_nop 0
    s_mul_i32 s94, s94, 1664525
    s_add_u32 s94, s94, 1013904223
    s_waitcnt lgkmcnt(0)
    s_mov_b32 s89, 65536
L_gb_poll:
    buffer_load_dwordx2 v[32:33], v5, s[44:47], s90 offen sc1
    s_waitcnt vmcnt(0)
    v_max_u32 v38, v32, v33
    v_cmp_eq_u32 vcc, -1, v38
    s_cbranch_vccz L_gb_ok
    s_sleep 4
    s_sub_u32 s89, s89, 1
    s_cbranch_scc0 L_gb_poll
L_gb_ok:
    v_lshlrev_b32 v140, 16, v32
    v_and_b32 v141, s84, v32
    v_lshlrev_b32 v142, 16, v33
    v_and_b32 v143, s84, v33
    s_mov_b32 s89, 65536
L_x1_poll:
    buffer_load_dwordx2 v[32:33], v6, s[44:47], s91 offen sc1
    s_waitcnt vmcnt(0)
    v_max_u32 v38, v32, v33
    v_cmp_eq_u32 vcc, -1, v38
    s_cbranch_vccz L_x1_ok
    s_mov_b64 exec, vcc
    s_sleep 1
    s_sub_u32 s89, s89, 1
    s_cbranch_scc0 L_x1_poll
L_x1_ok:
    s_mov_b64 exec, -1
    v_lshlrev_b32 v144, 16, v32
    v_and_b32 v145, s84, v32
    v_lshlrev_b32 v146, 16, v33
    v_and_b32 v147, s84, v33
    v_mov_b32 v16, 0
    v_mov_b32 v17, 0
    v_mov_b32 v18, 0
    v_mov_b32 v19, 0
    v_mov_b32 v20, 0
    v_mov_b32 v21, 0
    v_mov_b32 v22, 0
    v_mov_b32 v23, 0
    s_mov_b32 s90, 127
    s_mov_b32 s89, 65536
    v_mov_b32 v34, 0
    buffer_load_dwordx4 v[104:107], v3, s[76:79], s48 offen sc1
    buffer_load_dwordx4 v[108:111], v3, s[76:79], s49 offen sc1
    buffer_load_dwordx4 v[112:115], v3, s[76:79], s50 offen sc1
    buffer_load_dwordx4 v[116:119], v3, s[76:79], s51 offen sc1
    buffer_load_dwordx4 v[120:123], v3, s[76:79], s52 offen sc1
    buffer_load_dwordx4 v[124:127], v3, s[76:79], s53 offen sc1
    buffer_load_dwordx4 v[128:131], v3, s[76:79], s54 offen sc1
L_hid_poll:
    s_waitcnt vmcnt(6)
    s_bitcmp1_b32 s90, 0
    s_cbranch_scc0 L_hd_dm0
    v_max3_u32 v36, v104, v105, v106
    v_max_u32 v36, v36, v107
    v_cmp_eq_u32 vcc, -1, v36
    s_cbranch_vccz L_hd_ok0
    buffer_load_dwordx4 v[104:107], v3, s[76:79], s48 offen sc1
    s_branch L_hd_nx0
L_hd_ok0:
    v_mfma_f32_16x16x32_bf16 v[16:19], v[40:43], v[104:107], v[16:19]
    v_mfma_f32_16x16x32_bf16 v[20:23], v[44:47], v[104:107], v[20:23]
    s_bitset0_b32 s90, 0
    s_cmp_eq_u32 s90, 0
    s_cbranch_scc1 L_hid_ok
L_hd_dm0:
    buffer_load_dword v35, v34, s[76:79], 0 offen
L_hd_nx0:
    s_waitcnt vmcnt(6)
    s_bitcmp1_b32 s90, 1
    s_cbranch_scc0 L_hd_dm1
    v_max3_u32 v36, v108, v109, v110
    v_max_u32 v36, v36, v111
    v_cmp_eq_u32 vcc, -1, v36
    s_cbranch_vccz L_hd_ok1
    buffer_load_dwordx4 v[108:111], v3, s[76:79], s49 offen sc1
    s_branch L_hd_nx1
L_hd_ok1:
    v_mfma_f32_16x16x32_bf16 v[16:19], v[48:51], v[108:111], v[16:19]
    v_mfma_f32_16x16x32_bf16 v[20:23], v[52:55], v[108:111], v[20:23]
    s_bitset0_b32 s90, 1
    s_cmp_eq_u32 s90, 0
    s_cbranch_scc1 L_hid_ok
L_hd_dm1:
    buffer_load_dword v35, v34, s[76:79], 0 offen
L_hd_nx1:
    s_waitcnt vmcnt(6)
    s_bitcmp1_b32 s90, 2
    s_cbranch_scc0 L_hd_dm2
    v_max3_u32 v36, v112, v113, v114
    v_max_u32 v36, v36, v115
    v_cmp_eq_u32 vcc, -1, v36
    s_cbranch_vccz L_hd_ok2
    buffer_load_dwordx4 v[112:115], v3, s[76:79], s50 offen sc1
    s_branch L_hd_nx2
L_hd_ok2:
    v_mfma_f32_16x16x32_bf16 v[16:19], v[56:59], v[112:115], v[16:19]
    v_mfma_f32_16x16x32_bf16 v[20:23], v[60:63], v[112:115], v[20:23]
    s_bitset0_b32 s90, 2
    s_cmp_eq_u32 s90, 0
    s_cbranch_scc1 L_hid_ok
L_hd_dm2:
    buffer_load_dword v35, v34, s[76:79], 0 offen
L_hd_nx2:
    s_waitcnt vmcnt(6)
    s_bitcmp1_b32 s90, 3
    s_cbranch_scc0 L_hd_dm3
    v_max3_u32 v36, v116, v117, v118
    v_max_u32 v36, v36, v119
    v_cmp_eq_u32 vcc, -1, v36
    s_cbranch_vccz L_hd_ok3
    buffer_load_dwordx4 v[116:119], v3, s[76:79], s51 offen sc1
    s_branch L_hd_nx3
L_hd_ok3:
    v_mfma_f32_16x16x32_bf16 v[16:19], v[64:67], v[116:119], v[16:19]
    v_mfma_f32_16x16x32_bf16 v[20:23], v[68:71], v[116:119], v[20:23]
    s_bitset0_b32 s90, 3
    s_cmp_eq_u32 s90, 0
    s_cbranch_scc1 L_hid_ok
L_hd_dm3:
    buffer_load_dword v35, v34, s[76:79], 0 offen
L_hd_nx3:
    s_waitcnt vmcnt(6)
    s_bitcmp1_b32 s90, 4
    s_cbranch_scc0 L_hd_dm4
    v_max3_u32 v36, v120, v121, v122
    v_max_u32 v36, v36, v123
    v_cmp_eq_u32 vcc, -1, v36
    s_cbranch_vccz L_hd_ok4
    buffer_load_dwordx4 v[120:123], v3, s[76:79], s52 offen sc1
    s_branch L_hd_nx4
L_hd_ok4:
    v_mfma_f32_16x16x32_bf16 v[16:19], v[72:75], v[120:123], v[16:19]
    v_mfma_f32_16x16x32_bf16 v[20:23], v[76:79], v[120:123], v[20:23]
    s_bitset0_b32 s90, 4
    s_cmp_eq_u32 s90, 0
    s_cbranch_scc1 L_hid_ok
L_hd_dm4:
    buffer_load_dword v35, v34, s[76:79], 0 offen
L_hd_nx4:
    s_waitcnt vmcnt(6)
    s_bitcmp1_b32 s90, 5
    s_cbranch_scc0 L_hd_dm5
    v_max3_u32 v36, v124, v125, v126
    v_max_u32 v36, v36, v127
    v_cmp_eq_u32 vcc, -1, v36
    s_cbranch_vccz L_hd_ok5
    buffer_load_dwordx4 v[124:127], v3, s[76:79], s53 offen sc1
    s_branch L_hd_nx5
L_hd_ok5:
    v_mfma_f32_16x16x32_bf16 v[16:19], v[80:83], v[124:127], v[16:19]
    v_mfma_f32_16x16x32_bf16 v[20:23], v[84:87], v[124:127], v[20:23]
    s_bitset0_b32 s90, 5
    s_cmp_eq_u32 s90, 0
    s_cbranch_scc1 L_hid_ok
L_hd_dm5:
    buffer_load_dword v35, v34, s[76:79], 0 offen
L_hd_nx5:
    s_waitcnt vmcnt(6)
    s_bitcmp1_b32 s90, 6
    s_cbranch_scc0 L_hd_dm6
    v_max3_u32 v36, v128, v129, v130
    v_max_u32 v36, v36, v131
    v_cmp_eq_u32 vcc, -1, v36
    s_cbranch_vccz L_hd_ok6
    buffer_load_dwordx4 v[128:131], v3, s[76:79], s54 offen sc1
    s_branch L_hd_nx6
L_hd_ok6:
    v_mfma_f32_16x16x32_bf16 v[16:19], v[88:91], v[128:131], v[16:19]
    v_mfma_f32_16x16x32_bf16 v[20:23], v[92:95], v[128:131], v[20:23]
    s_bitset0_b32 s90, 6
    s_cmp_eq_u32 s90, 0
    s_cbranch_scc1 L_hid_ok
L_hd_dm6:
    buffer_load_dword v35, v34, s[76:79], 0 offen
L_hd_nx6:
    s_sub_u32 s89, s89, 1
    s_cbranch_scc0 L_hid_poll
L_hid_ok:
    s_nop 7
    ds_write_b128 v10, v[16:19] offset:0
    ds_write_b128 v10, v[20:23] offset:1024
    s_mov_b64 exec, 1
    v_mov_b32 v14, 1
    ds_add_rtn_u32 v14, v13, v14 offset:0
    s_mov_b64 exec, -1
    ds_read_b128 v[40:43], v11 offset:0
    ds_read_b128 v[44:47], v11 offset:640
    ds_read_b128 v[48:51], v11 offset:14336
    ds_read_b128 v[52:55], v11 offset:14976
    ds_read_b128 v[56:59], v11 offset:28672
    ds_read_b128 v[60:63], v11 offset:29312
    ds_read_b128 v[64:67], v11 offset:43008
    ds_read_b128 v[68:71], v11 offset:43648
    s_waitcnt lgkmcnt(8)
    v_readfirstlane_b32 s88, v14
    s_nop 0
    s_cmp_lg_u32 s88, 3
    s_cbranch_scc1 L_ctrl_end
    s_waitcnt lgkmcnt(0)
    v_pk_add_f32 v[40:41], v[40:41], v[44:45]
    v_pk_add_f32 v[42:43], v[42:43], v[46:47]
    v_pk_add_f32 v[48:49], v[48:49], v[52:53]
    v_pk_add_f32 v[50:51], v[50:51], v[54:55]
    v_pk_add_f32 v[56:57], v[56:57], v[60:61]
    v_pk_add_f32 v[58:59], v[58:59], v[62:63]
    v_pk_add_f32 v[64:65], v[64:65], v[68:69]
    v_pk_add_f32 v[66:67], v[66:67], v[70:71]
    v_pk_add_f32 v[40:41], v[40:41], v[48:49]
    v_pk_add_f32 v[42:43], v[42:43], v[50:51]
    v_pk_add_f32 v[56:57], v[56:57], v[64:65]
    v_pk_add_f32 v[58:59], v[58:59], v[66:67]
    v_pk_add_f32 v[40:41], v[40:41], v[56:57]
    v_pk_add_f32 v[42:43], v[42:43], v[58:59]
    v_cvt_pk_bf16_f32 v40, 0, v40
    v_cvt_pk_bf16_f32 v41, 0, v41
    v_cvt_pk_bf16_f32 v42, 0, v42
    v_cvt_pk_bf16_f32 v43, 0, v43
    v_pk_mul_f32 v[40:41], v[40:41], v[140:141]
    v_pk_mul_f32 v[42:43], v[42:43], v[142:143]
    v_cvt_pk_bf16_f32 v40, 0, v40
    v_cvt_pk_bf16_f32 v41, 0, v41
    v_cvt_pk_bf16_f32 v42, 0, v42
    v_cvt_pk_bf16_f32 v43, 0, v43
    v_pk_add_f32 v[40:41], v[40:41], v[144:145]
    v_pk_add_f32 v[42:43], v[42:43], v[146:147]
    v_cvt_pk_bf16_f32 v28, v40, v41
    v_cvt_pk_bf16_f32 v29, v42, v43
    s_mov_b32 exec_hi, 0
    buffer_store_dwordx2 v[28:29], v6, s[80:83], s9 offen
    s_cmp_lg_u32 s8, 0
    s_cbranch_scc1 L_noepoch
    s_mov_b64 exec, 1
    v_mov_b32 v20, 0
    v_mov_b32 v21, s94
    buffer_store_dword v21, v20, s[44:47], 0 offen sc1
L_noepoch:
    s_mov_b64 exec, -1
    s_branch L_ctrl_end
L_role_red:
    s_mov_b32 s60, s16
    s_mov_b32 s61, s17
    s_mov_b32 s62, 10240
    s_mov_b32 s63, 0x20000
    v_lshlrev_b32 v8, 3, v2
    s_mul_i32 s9, s8, 1280
    buffer_load_dwordx2 v[26:27], v8, s[60:63], s9 offen
    buffer_load_dwordx2 v[28:29], v8, s[60:63], s9 offen offset:512
    buffer_load_dword v30, v12, s[60:63], s9 offen offset:1024
    s_lshl_b32 s90, s8, 14
    s_lshl_b32 s85, s3, 12
    s_add_u32 s90, s90, s85
    s_add_u32 s90, s90, 32768
    s_waitcnt vmcnt(0)
    v_readfirstlane_b32 s94, v167
    s_nop 0
    s_mul_i32 s94, s94, 1664525
    s_add_u32 s94, s94, 1013904223
    v_lshlrev_b32 v120, 16, v26
    v_and_b32 v121, s84, v26
    v_lshlrev_b32 v122, 16, v27
    v_and_b32 v123, s84, v27
    v_lshlrev_b32 v124, 16, v28
    v_and_b32 v125, s84, v28
    v_lshlrev_b32 v126, 16, v29
    v_and_b32 v127, s84, v29
    v_lshlrev_b32 v128, 16, v30
    v_and_b32 v129, s84, v30
    s_mov_b32 s89, 1048576
L_lw_55:
    ds_read_b32 v14, v13 offset:16
    s_waitcnt lgkmcnt(0)
    v_readfirstlane_b32 s88, v14
    s_nop 0
    s_cmp_ge_u32 s88, 1
    s_cbranch_scc1 L_lwd_56
    s_sleep 8
    s_sub_u32 s89, s89, 1
    s_cbranch_scc0 L_lw_55
L_lwd_56:
    s_mov_b32 s89, 65536
L_qall_poll:
    buffer_load_dwordx4 v[40:43], v7, s[44:47], s90 offen offset:0 sc1
    buffer_load_dwordx4 v[44:47], v7, s[44:47], s90 offen offset:1024 sc1
    buffer_load_dwordx4 v[48:51], v7, s[44:47], s90 offen offset:2048 sc1
    buffer_load_dwordx4 v[52:55], v7, s[44:47], s90 offen offset:3072 sc1
    s_waitcnt vmcnt(0)
    v_xor_b32 v36, s94, v41
    v_xor_b32 v37, s94, v43
    v_or_b32 v38, v36, v37
    v_xor_b32 v36, s94, v45
    v_xor_b32 v37, s94, v47
    v_or3_b32 v38, v38, v36, v37
    v_xor_b32 v36, s94, v49
    v_xor_b32 v37, s94, v51
    v_or3_b32 v38, v38, v36, v37
    v_xor_b32 v36, s94, v53
    v_xor_b32 v37, s94, v55
    v_or3_b32 v38, v38, v36, v37
    v_cmp_ne_u32 vcc, 0, v38
    s_cbranch_vccz L_qall_ok
    s_sleep 8
    s_sub_u32 s89, s89, 1
    s_cbranch_scc0 L_qall_poll
L_qall_ok:
    s_mul_i32 s90, s8, 5120
    s_add_u32 s90, s90, 217088
    s_mov_b32 s89, 65536
L_modo_poll:
    buffer_load_dwordx2 v[40:41], v8, s[44:47], s90 offen offset:0 sc1
    buffer_load_dwordx2 v[42:43], v8, s[44:47], s90 offen offset:512 sc1
    buffer_load_dword v44, v12, s[44:47], s90 offen offset:1024 sc1
    buffer_load_dwordx2 v[46:47], v8, s[44:47], s90 offen offset:1280 sc1
    buffer_load_dwordx2 v[48:49], v8, s[44:47], s90 offen offset:1792 sc1
    buffer_load_dword v50, v12, s[44:47], s90 offen offset:2304 sc1
    buffer_load_dwordx2 v[52:53], v8, s[44:47], s90 offen offset:2560 sc1
    buffer_load_dwordx2 v[54:55], v8, s[44:47], s90 offen offset:3072 sc1
    buffer_load_dword v56, v12, s[44:47], s90 offen offset:3584 sc1
    s_waitcnt vmcnt(0)
    v_max3_u32 v38, v40, v41, v42
    v_max3_u32 v38, v38, v43, v44
    v_max3_u32 v38, v38, v46, v47
    v_max3_u32 v38, v38, v48, v49
    v_max3_u32 v38, v38, v50, v52
    v_max3_u32 v38, v38, v53, v54
    v_max3_u32 v38, v38, v55, v56
    v_cmp_eq_u32 vcc, -1, v38
    s_cbranch_vccz L_modo_ok
    s_sleep 8
    s_sub_u32 s89, s89, 1
    s_cbranch_scc0 L_modo_poll
L_modo_ok:
    v_lshlrev_b32 v130, 16, v40
    v_and_b32 v131, s84, v40
    v_lshlrev_b32 v132, 16, v41
    v_and_b32 v133, s84, v41
    v_lshlrev_b32 v134, 16, v42
    v_and_b32 v135, s84, v42
    v_lshlrev_b32 v136, 16, v43
    v_and_b32 v137, s84, v43
    v_lshlrev_b32 v138, 16, v44
    v_and_b32 v139, s84, v44
    v_lshlrev_b32 v140, 16, v46
    v_and_b32 v141, s84, v46
    v_lshlrev_b32 v142, 16, v47
    v_and_b32 v143, s84, v47
    v_lshlrev_b32 v144, 16, v48
    v_and_b32 v145, s84, v48
    v_lshlrev_b32 v146, 16, v49
    v_and_b32 v147, s84, v49
    v_lshlrev_b32 v148, 16, v50
    v_and_b32 v149, s84, v50
    v_lshlrev_b32 v150, 16, v52
    v_and_b32 v151, s84, v52
    v_lshlrev_b32 v152, 16, v53
    v_and_b32 v153, s84, v53
    v_lshlrev_b32 v154, 16, v54
    v_and_b32 v155, s84, v54
    v_lshlrev_b32 v156, 16, v55
    v_and_b32 v157, s84, v55
    v_lshlrev_b32 v158, 16, v56
    v_and_b32 v159, s84, v56
    v_pk_add_f32 v[150:151], v[150:151], 1.0 op_sel_hi:[1,0]
    v_cvt_pk_bf16_f32 v26, v150, v151
    v_lshlrev_b32 v150, 16, v26
    v_and_b32 v151, s84, v26
    v_pk_add_f32 v[152:153], v[152:153], 1.0 op_sel_hi:[1,0]
    v_cvt_pk_bf16_f32 v26, v152, v153
    v_lshlrev_b32 v152, 16, v26
    v_and_b32 v153, s84, v26
    v_pk_add_f32 v[154:155], v[154:155], 1.0 op_sel_hi:[1,0]
    v_cvt_pk_bf16_f32 v26, v154, v155
    v_lshlrev_b32 v154, 16, v26
    v_and_b32 v155, s84, v26
    v_pk_add_f32 v[156:157], v[156:157], 1.0 op_sel_hi:[1,0]
    v_cvt_pk_bf16_f32 v26, v156, v157
    v_lshlrev_b32 v156, 16, v26
    v_and_b32 v157, s84, v26
    v_pk_add_f32 v[158:159], v[158:159], 1.0 op_sel_hi:[1,0]
    v_cvt_pk_bf16_f32 v26, v158, v159
    v_lshlrev_b32 v158, 16, v26
    v_and_b32 v159, s84, v26
    v_mov_b32 v16, 0
    v_mov_b32 v17, 0
    v_mov_b32 v18, 0
    v_mov_b32 v19, 0
    v_mov_b32 v20, 0
    v_mov_b32 v21, 0
    v_mov_b32 v22, 0
    v_mov_b32 v23, 0
    v_mov_b32 v24, 0
    v_mov_b32 v25, 0
    s_lshl_b32 s91, s8, 5
    s_lshl_b32 s85, s3, 3
    s_add_u32 s91, s91, s85
    s_mul_i32 s91, s91, 2560
    s_add_u32 s91, s91, 327680
    s_mul_i32 s87, s3, 2560
    v_add_u32 v10, s87, v7
    v_add_u32 v11, s87, v8
    s_add_u32 s92, s9, 163840
    s_add_u32 s93, s9, 176128
    s_mov_b32 s89, 1048576
L_lw_57:
    ds_read_b32 v14, v13 offset:20
    s_waitcnt lgkmcnt(0)
    v_readfirstlane_b32 s88, v14
    s_nop 0
    s_cmp_ge_u32 s88, 1
    s_cbranch_scc1 L_lwd_58
    s_sleep 8
    s_sub_u32 s89, s89, 1
    s_cbranch_scc0 L_lw_57
L_lwd_58:
    s_mov_b32 s90, 0xff
    s_mov_b32 s89, 65536
    v_and_b32 v34, 7, v2
    v_mul_u32_u24 v34, 2560, v34
    s_mov_b32 s86, 0
L_p_poll:
    s_mov_b32 s95, s90
    s_cmp_lg_u32 s86, 0
    s_cbranch_scc1 L_p_fetch
    ds_read_b32 v14, v13 offset:36
    s_waitcnt lgkmcnt(0)
    v_readfirstlane_b32 s88, v14
    s_nop 0
    s_cmp_ge_u32 s88, 8
    s_cselect_b32 s86, 1, 0
    s_cbranch_scc1 L_p_fetch
    s_sleep 4
    buffer_load_dword v35, v34, s[44:47], s91 offen offset:2556 sc1
    s_waitcnt vmcnt(0)
    v_cmp_ne_u32 vcc, -1, v35
    s_nop 1
    s_and_b32 s95, s90, vcc_lo
    s_cbranch_scc0 L_p_next
L_p_fetch:
    s_bcnt1_i32_b32 s85, s90
    s_and_b32 s85, s85, s86
    s_bcnt1_i32_b32 s88, s90
    s_cmp_eq_u32 s88, s85
    s_cbranch_scc1 L_p_one
    s_bitcmp1_b32 s95, 0
    s_cbranch_scc0 L_p_sk0
    s_add_u32 s85, s91, 0
    buffer_load_dwordx4 v[40:43], v7, s[44:47], s85 offen sc1
    buffer_load_dwordx4 v[44:47], v7, s[44:47], s85 offen offset:1024 sc1
    buffer_load_dwordx2 v[48:49], v8, s[44:47], s85 offen offset:2048 sc1
L_p_sk0:
    s_bitcmp1_b32 s95, 1
    s_cbranch_scc0 L_p_sk1
    s_add_u32 s85, s91, 2560
    buffer_load_dwordx4 v[50:53], v7, s[44:47], s85 offen sc1
    buffer_load_dwordx4 v[54:57], v7, s[44:47], s85 offen offset:1024 sc1
    buffer_load_dwordx2 v[58:59], v8, s[44:47], s85 offen offset:2048 sc1
L_p_sk1:
    s_bitcmp1_b32 s95, 2
    s_cbranch_scc0 L_p_sk2
    s_add_u32 s85, s91, 5120
    buffer_load_dwordx4 v[60:63], v7, s[44:47], s85 offen sc1
    buffer_load_dwordx4 v[64:67], v7, s[44:47], s85 offen offset:1024 sc1
    buffer_load_dwordx2 v[68:69], v8, s[44:47], s85 offen offset:2048 sc1
L_p_sk2:
    s_bitcmp1_b32 s95, 3
    s_cbranch_scc0 L_p_sk3
    s_add_u32 s85, s91, 7680
    buffer_load_dwordx4 v[70:73], v7, s[44:47], s85 offen sc1
    buffer_load_dwordx4 v[74:77], v7, s[44:47], s85 offen offset:1024 sc1
    buffer_load_dwordx2 v[78:79], v8, s[44:47], s85 offen offset:2048 sc1
L_p_sk3:
    s_bitcmp1_b32 s95, 4
    s_cbranch_scc0 L_p_sk4
    s_add_u32 s85, s91, 10240
    buffer_load_dwordx4 v[80:83], v7, s[44:47], s85 offen sc1
    buffer_load_dwordx4 v[84:87], v7, s[44:47], s85 offen offset:1024 sc1
    buffer_load_dwordx2 v[88:89], v8, s[44:47], s85 offen offset:2048 sc1
L_p_sk4:
    s_bitcmp1_b32 s95, 5
    s_cbranch_scc0 L_p_sk5
    s_add_u32 s85, s91, 12800
    buffer_load_dwordx4 v[90:93], v7, s[44:47], s85 offen sc1
    buffer_load_dwordx4 v[94:97], v7, s[44:47], s85 offen offset:1024 sc1
    buffer_load_dwordx2 v[98:99], v8, s[44:47], s85 offen offset:2048 sc1
L_p_sk5:
    s_bitcmp1_b32 s95, 6
    s_cbranch_scc0 L_p_sk6
    s_add_u32 s85, s91, 15360
    buffer_load_dwordx4 v[100:103], v7, s[44:47], s85 offen sc1
    buffer_load_dwordx4 v[104:107], v7, s[44:47], s85 offen offset:1024 sc1
    buffer_load_dwordx2 v[108:109], v8, s[44:47], s85 offen offset:2048 sc1
L_p_sk6:
    s_bitcmp1_b32 s95, 7
    s_cbranch_scc0 L_p_sk7
    s_add_u32 s85, s91, 17920
    buffer_load_dwordx4 v[110:113], v7, s[44:47], s85 offen sc1
    buffer_load_dwordx4 v[114:117], v7, s[44:47], s85 offen offset:1024 sc1
    buffer_load_dwordx2 v[118:119], v8, s[44:47], s85 offen offset:2048 sc1
L_p_sk7:
    s_waitcnt vmcnt(0)
    s_bitcmp1_b32 s95, 0
    s_cbranch_scc0 L_p_ck0
    v_max3_u32 v36, v40, v41, v42
    v_max3_u32 v37, v43, v44, v45
    v_max3_u32 v36, v36, v46, v47
    v_max3_u32 v37, v37, v48, v49
    v_max_u32 v36, v36, v37
    v_cmp_eq_u32 vcc, -1, v36
    s_cbranch_vccnz L_p_ck0
    s_bitset0_b32 s90, 0
    v_pk_add_f32 v[16:17], v[16:17], v[40:41]
    v_pk_add_f32 v[18:19], v[18:19], v[42:43]
    v_pk_add_f32 v[20:21], v[20:21], v[44:45]
    v_pk_add_f32 v[22:23], v[22:23], v[46:47]
    v_pk_add_f32 v[24:25], v[24:25], v[48:49]
L_p_ck0:
    s_bitcmp1_b32 s95, 1
    s_cbranch_scc0 L_p_ck1
    v_max3_u32 v36, v50, v51, v52
    v_max3_u32 v37, v53, v54, v55
    v_max3_u32 v36, v36, v56, v57
    v_max3_u32 v37, v37, v58, v59
    v_max_u32 v36, v36, v37
    v_cmp_eq_u32 vcc, -1, v36
    s_cbranch_vccnz L_p_ck1
    s_bitset0_b32 s90, 1
    v_pk_add_f32 v[16:17], v[16:17], v[50:51]
    v_pk_add_f32 v[18:19], v[18:19], v[52:53]
    v_pk_add_f32 v[20:21], v[20:21], v[54:55]
    v_pk_add_f32 v[22:23], v[22:23], v[56:57]
    v_pk_add_f32 v[24:25], v[24:25], v[58:59]
L_p_ck1:
    s_bitcmp1_b32 s95, 2
    s_cbranch_scc0 L_p_ck2
    v_max3_u32 v36, v60, v61, v62
    v_max3_u32 v37, v63, v64, v65
    v_max3_u32 v36, v36, v66, v67
    v_max3_u32 v37, v37, v68, v69
    v_max_u32 v36, v36, v37
    v_cmp_eq_u32 vcc, -1, v36
    s_cbranch_vccnz L_p_ck2
    s_bitset0_b32 s90, 2
    v_pk_add_f32 v[16:17], v[16:17], v[60:61]
    v_pk_add_f32 v[18:19], v[18:19], v[62:63]
    v_pk_add_f32 v[20:21], v[20:21], v[64:65]
    v_pk_add_f32 v[22:23], v[22:23], v[66:67]
    v_pk_add_f32 v[24:25], v[24:25], v[68:69]
L_p_ck2:
    s_bitcmp1_b32 s95, 3
    s_cbranch_scc0 L_p_ck3
    v_max3_u32 v36, v70, v71, v72
    v_max3_u32 v37, v73, v74, v75
    v_max3_u32 v36, v36, v76, v77
    v_max3_u32 v37, v37, v78, v79
    v_max_u32 v36, v36, v37
    v_cmp_eq_u32 vcc, -1, v36
    s_cbranch_vccnz L_p_ck3
    s_bitset0_b32 s90, 3
    v_pk_add_f32 v[16:17], v[16:17], v[70:71]
    v_pk_add_f32 v[18:19], v[18:19], v[72:73]
    v_pk_add_f32 v[20:21], v[20:21], v[74:75]
    v_pk_add_f32 v[22:23], v[22:23], v[76:77]
    v_pk_add_f32 v[24:25], v[24:25], v[78:79]
L_p_ck3:
    s_bitcmp1_b32 s95, 4
    s_cbranch_scc0 L_p_ck4
    v_max3_u32 v36, v80, v81, v82
    v_max3_u32 v37, v83, v84, v85
    v_max3_u32 v36, v36, v86, v87
    v_max3_u32 v37, v37, v88, v89
    v_max_u32 v36, v36, v37
    v_cmp_eq_u32 vcc, -1, v36
    s_cbranch_vccnz L_p_ck4
    s_bitset0_b32 s90, 4
    v_pk_add_f32 v[16:17], v[16:17], v[80:81]
    v_pk_add_f32 v[18:19], v[18:19], v[82:83]
    v_pk_add_f32 v[20:21], v[20:21], v[84:85]
    v_pk_add_f32 v[22:23], v[22:23], v[86:87]
    v_pk_add_f32 v[24:25], v[24:25], v[88:89]
L_p_ck4:
    s_bitcmp1_b32 s95, 5
    s_cbranch_scc0 L_p_ck5
    v_max3_u32 v36, v90, v91, v92
    v_max3_u32 v37, v93, v94, v95
    v_max3_u32 v36, v36, v96, v97
    v_max3_u32 v37, v37, v98, v99
    v_max_u32 v36, v36, v37
    v_cmp_eq_u32 vcc, -1, v36
    s_cbranch_vccnz L_p_ck5
    s_bitset0_b32 s90, 5
    v_pk_add_f32 v[16:17], v[16:17], v[90:91]
    v_pk_add_f32 v[18:19], v[18:19], v[92:93]
    v_pk_add_f32 v[20:21], v[20:21], v[94:95]
    v_pk_add_f32 v[22:23], v[22:23], v[96:97]
    v_pk_add_f32 v[24:25], v[24:25], v[98:99]
L_p_ck5:
    s_bitcmp1_b32 s95, 6
    s_cbranch_scc0 L_p_ck6
    v_max3_u32 v36, v100, v101, v102
    v_max3_u32 v37, v103, v104, v105
    v_max3_u32 v36, v36, v106, v107
    v_max3_u32 v37, v37, v108, v109
    v_max_u32 v36, v36, v37
    v_cmp_eq_u32 vcc, -1, v36
    s_cbranch_vccnz L_p_ck6
    s_bitset0_b32 s90, 6
    v_pk_add_f32 v[16:17], v[16:17], v[100:101]
    v_pk_add_f32 v[18:19], v[18:19], v[102:103]
    v_pk_add_f32 v[20:21], v[20:21], v[104:105]
    v_pk_add_f32 v[22:23], v[22:23], v[106:107]
    v_pk_add_f32 v[24:25], v[24:25], v[108:109]
L_p_ck6:
    s_bitcmp1_b32 s95, 7
    s_cbranch_scc0 L_p_ck7
    v_max3_u32 v36, v110, v111, v112
    v_max3_u32 v37, v113, v114, v115
    v_max3_u32 v36, v36, v116, v117
    v_max3_u32 v37, v37, v118, v119
    v_max_u32 v36, v36, v37
    v_cmp_eq_u32 vcc, -1, v36
    s_cbranch_vccnz L_p_ck7
    s_bitset0_b32 s90, 7
    v_pk_add_f32 v[16:17], v[16:17], v[110:111]
    v_pk_add_f32 v[18:19], v[18:19], v[112:113]
    v_pk_add_f32 v[20:21], v[20:21], v[114:115]
    v_pk_add_f32 v[22:23], v[22:23], v[116:117]
    v_pk_add_f32 v[24:25], v[24:25], v[118:119]
L_p_ck7:
    s_cmp_eq_u32 s90, 0
    s_cbranch_scc1 L_p_ok
L_p_next:
    s_sub_u32 s89, s89, 1
    s_cbranch_scc0 L_p_poll
    s_branch L_p_ok
L_p_one:
    s_ff1_i32_b32 s85, s90
    s_mul_i32 s85, s85, 2560
    s_add_u32 s85, s85, s91
L_p_one_l:
    buffer_load_dwordx4 v[110:113], v7, s[44:47], s85 offen sc1
    buffer_load_dwordx4 v[114:117], v7, s[44:47], s85 offen offset:1024 sc1
    buffer_load_dwordx2 v[118:119], v8, s[44:47], s85 offen offset:2048 sc1
    s_sub_u32 s89, s89, 1
    s_cbranch_scc1 L_p_ok
    s_waitcnt vmcnt(0)
    v_max3_u32 v36, v110, v111, v112
    v_max3_u32 v37, v113, v114, v115
    v_max3_u32 v36, v36, v116, v117
    v_max3_u32 v37, v37, v118, v119
    v_max_u32 v36, v36, v37
    v_cmp_eq_u32 vcc, -1, v36
    s_cbranch_vccnz L_p_one_l
    v_pk_add_f32 v[16:17], v[16:17], v[110:111]
    v_pk_add_f32 v[18:19], v[18:19], v[112:113]
    v_pk_add_f32 v[20:21], v[20:21], v[114:115]
    v_pk_add_f32 v[22:23], v[22:23], v[116:117]
    v_pk_add_f32 v[24:25], v[24:25], v[118:119]
L_p_ok:
    ds_write_b128 v10, v[16:19] offset:0
    ds_write_b128 v10, v[20:23] offset:1024
    ds_write_b64 v11, v[24:25] offset:2048
    s_mov_b64 exec, 1
    v_mov_b32 v14, 1
    ds_add_rtn_u32 v14, v13, v14 offset:0
    s_mov_b64 exec, -1
    ds_read_b128 v[40:43], v7 offset:0
    ds_read_b128 v[44:47], v7 offset:1024
    ds_read_b64 v[48:49], v8 offset:2048
    ds_read_b128 v[50:53], v7 offset:2560
    ds_read_b128 v[54:57], v7 offset:3584
    ds_read_b64 v[58:59], v8 offset:4608
    ds_read_b128 v[60:63], v7 offset:5120
    ds_read_b128 v[64:67], v7 offset:6144
    ds_read_b64 v[68:69], v8 offset:7168
    ds_read_b128 v[70:73], v7 offset:7680
    ds_read_b128 v[74:77], v7 offset:8704
    ds_read_b64 v[78:79], v8 offset:9728
    s_waitcnt lgkmcnt(12)
    v_readfirstlane_b32 s88, v14
    s_nop 0
    s_cmp_lg_u32 s88, 3
    s_cbranch_scc1 L_ctrl_end
    s_waitcnt lgkmcnt(0)
    v_pk_add_f32 v[40:41], v[40:41], v[50:51]
    v_pk_add_f32 v[42:43], v[42:43], v[52:53]
    v_pk_add_f32 v[44:45], v[44:45], v[54:55]
    v_pk_add_f32 v[46:47], v[46:47], v[56:57]
    v_pk_add_f32 v[48:49], v[48:49], v[58:59]
    v_pk_add_f32 v[60:61], v[60:61], v[70:71]
    v_pk_add_f32 v[62:63], v[62:63], v[72:73]
    v_pk_add_f32 v[64:65], v[64:65], v[74:75]
    v_pk_add_f32 v[66:67], v[66:67], v[76:77]
    v_pk_add_f32 v[68:69], v[68:69], v[78:79]
    v_pk_add_f32 v[40:41], v[40:41], v[60:61]
    v_pk_add_f32 v[42:43], v[42:43], v[62:63]
    v_pk_add_f32 v[44:45], v[44:45], v[64:65]
    v_pk_add_f32 v[46:47], v[46:47], v[66:67]
    v_pk_add_f32 v[48:49], v[48:49], v[68:69]
L_red_epi:
    v_cvt_pk_bf16_f32 v40, 0, v40
    v_cvt_pk_bf16_f32 v41, 0, v41
    v_cvt_pk_bf16_f32 v42, 0, v42
    v_cvt_pk_bf16_f32 v43, 0, v43
    v_cvt_pk_bf16_f32 v44, 0, v44
    v_cvt_pk_bf16_f32 v45, 0, v45
    v_cvt_pk_bf16_f32 v46, 0, v46
    v_cvt_pk_bf16_f32 v47, 0, v47
    v_cvt_pk_bf16_f32 v48, 0, v48
    v_cvt_pk_bf16_f32 v49, 0, v49
    v_pk_mul_f32 v[40:41], v[40:41], v[130:131]
    v_pk_mul_f32 v[42:43], v[42:43], v[132:133]
    v_pk_mul_f32 v[44:45], v[44:45], v[134:135]
    v_pk_mul_f32 v[46:47], v[46:47], v[136:137]
    v_pk_mul_f32 v[48:49], v[48:49], v[138:139]
    v_cvt_pk_bf16_f32 v40, 0, v40
    v_cvt_pk_bf16_f32 v41, 0, v41
    v_cvt_pk_bf16_f32 v42, 0, v42
    v_cvt_pk_bf16_f32 v43, 0, v43
    v_cvt_pk_bf16_f32 v44, 0, v44
    v_cvt_pk_bf16_f32 v45, 0, v45
    v_cvt_pk_bf16_f32 v46, 0, v46
    v_cvt_pk_bf16_f32 v47, 0, v47
    v_cvt_pk_bf16_f32 v48, 0, v48
    v_cvt_pk_bf16_f32 v49, 0, v49
    v_pk_add_f32 v[40:41], v[40:41], v[120:121]
    v_pk_add_f32 v[42:43], v[42:43], v[122:123]
    v_pk_add_f32 v[44:45], v[44:45], v[124:125]
    v_pk_add_f32 v[46:47], v[46:47], v[126:127]
    v_pk_add_f32 v[48:49], v[48:49], v[128:129]
    v_cvt_pk_bf16_f32 v40, 0, v40
    v_cvt_pk_bf16_f32 v41, 0, v41
    v_cvt_pk_bf16_f32 v42, 0, v42
    v_cvt_pk_bf16_f32 v43, 0, v43
    v_cvt_pk_bf16_f32 v44, 0, v44
    v_cvt_pk_bf16_f32 v45, 0, v45
    v_cvt_pk_bf16_f32 v46, 0, v46
    v_cvt_pk_bf16_f32 v47, 0, v47
    v_cvt_pk_bf16_f32 v48, 0, v48
    v_cvt_pk_bf16_f32 v49, 0, v49
    v_readlane_b32 s86, v40, 0
    s_nop 1
    v_pk_add_f32 v[36:37], v[40:41], s[86:87] op_sel_hi:[1,0] neg_lo:[0,1] neg_hi:[0,1]
    v_pk_mul_f32 v[34:35], v[36:37], v[36:37]
    v_add_f32 v32, v36, v37
    v_pk_add_f32 v[36:37], v[42:43], s[86:87] op_sel_hi:[1,0] neg_lo:[0,1] neg_hi:[0,1]
    v_pk_fma_f32 v[34:35], v[36:37], v[36:37], v[34:35]
    v_add_f32 v33, v36, v37
    v_add_f32 v32, v32, v33
    v_pk_add_f32 v[36:37], v[44:45], s[86:87] op_sel_hi:[1,0] neg_lo:[0,1] neg_hi:[0,1]
    v_pk_fma_f32 v[34:35], v[36:37], v[36:37], v[34:35]
    v_add_f32 v33, v36, v37
    v_add_f32 v32, v32, v33
    v_pk_add_f32 v[36:37], v[46:47], s[86:87] op_sel_hi:[1,0] neg_lo:[0,1] neg_hi:[0,1]
    v_pk_fma_f32 v[34:35], v[36:37], v[36:37], v[34:35]
    v_add_f32 v33, v36, v37
    v_add_f32 v32, v32, v33
    v_pk_add_f32 v[36:37], v[48:49], s[86:87] op_sel_hi:[1,0] neg_lo:[0,1] neg_hi:[0,1]
    v_pk_fma_f32 v[34:35], v[36:37], v[36:37], v[34:35]
    v_add_f32 v33, v36, v37
    v_add_f32 v32, v32, v33
    v_add_f32 v33, v34, v35
    s_nop 0
    v_add_f32_dpp v32, v32, v32 row_ror:8 row_mask:0xf bank_mask:0xf
    v_add_f32_dpp v33, v33, v33 row_ror:8 row_mask:0xf bank_mask:0xf
    s_nop 0
    v_add_f32_dpp v32, v32, v32 row_ror:4 row_mask:0xf bank_mask:0xf
    v_add_f32_dpp v33, v33, v33 row_ror:4 row_mask:0xf bank_mask:0xf
    s_nop 0
    v_add_f32_dpp v32, v32, v32 row_ror:2 row_mask:0xf bank_mask:0xf
    v_add_f32_dpp v33, v33, v33 row_ror:2 row_mask:0xf bank_mask:0xf
    s_nop 0
    v_add_f32_dpp v32, v32, v32 row_ror:1 row_mask:0xf bank_mask:0xf
    v_add_f32_dpp v33, v33, v33 row_ror:1 row_mask:0xf bank_mask:0xf
    s_nop 0
    v_add_f32_dpp v32, v32, v32 row_bcast:15 row_mask:0xa bank_mask:0xf
    v_add_f32_dpp v33, v33, v33 row_bcast:15 row_mask:0xa bank_mask:0xf
    s_nop 0
    v_add_f32_dpp v32, v32, v32 row_bcast:31 row_mask:0xc bank_mask:0xf
    v_add_f32_dpp v33, v33, v33 row_bcast:31 row_mask:0xc bank_mask:0xf
    v_mul_f32 v32, 0x3acccccd, v32
    v_mul_f32 v33, 0x3acccccd, v33
    v_fma_f32 v33, -v32, v32, v33
    v_add_f32 v32, s86, v32
    v_max_f32 v33, 0, v33
    v_cvt_pk_bf16_f32 v32, 0, v32
    v_cvt_pk_bf16_f32 v33, 0, v33
    v_readlane_b32 s96, v32, 63
    v_add_f32 v33, 0x3727c5ac, v33
    v_cvt_pk_bf16_f32 v33, 0, v33
    v_sqrt_f32 v33, v33
    s_nop 0
    v_cvt_pk_bf16_f32 v33, 0, v33
    v_rcp_f32 v33, v33
    s_nop 0
    v_readlane_b32 s98, v33, 63
    v_cvt_pk_bf16_f32 v160, v40, v41
    v_cvt_pk_bf16_f32 v161, v42, v43
    v_cvt_pk_bf16_f32 v162, v44, v45
    v_cvt_pk_bf16_f32 v163, v46, v47
    v_cvt_pk_bf16_f32 v164, v48, v49
    v_pk_add_f32 v[40:41], v[40:41], s[96:97] op_sel_hi:[1,0] neg_lo:[0,1] neg_hi:[0,1]
    v_pk_add_f32 v[42:43], v[42:43], s[96:97] op_sel_hi:[1,0] neg_lo:[0,1] neg_hi:[0,1]
    v_pk_add_f32 v[44:45], v[44:45], s[96:97] op_sel_hi:[1,0] neg_lo:[0,1] neg_hi:[0,1]
    v_pk_add_f32 v[46:47], v[46:47], s[96:97] op_sel_hi:[1,0] neg_lo:[0,1] neg_hi:[0,1]
    v_pk_add_f32 v[48:49], v[48:49], s[96:97] op_sel_hi:[1,0] neg_lo:[0,1] neg_hi:[0,1]
    v_cvt_pk_bf16_f32 v40, 0, v40
    v_cvt_pk_bf16_f32 v41, 0, v41
    v_cvt_pk_bf16_f32 v42, 0, v42
    v_cvt_pk_bf16_f32 v43, 0, v43
    v_cvt_pk_bf16_f32 v44, 0, v44
    v_cvt_pk_bf16_f32 v45, 0, v45
    v_cvt_pk_bf16_f32 v46, 0, v46
    v_cvt_pk_bf16_f32 v47, 0, v47
    v_cvt_pk_bf16_f32 v48, 0, v48
    v_cvt_pk_bf16_f32 v49, 0, v49
    v_pk_mul_f32 v[40:41], v[40:41], s[98:99] op_sel_hi:[1,0]
    v_pk_mul_f32 v[42:43], v[42:43], s[98:99] op_sel_hi:[1,0]
    v_pk_mul_f32 v[44:45], v[44:45], s[98:99] op_sel_hi:[1,0]
    v_pk_mul_f32 v[46:47], v[46:47], s[98:99] op_sel_hi:[1,0]
    v_pk_mul_f32 v[48:49], v[48:49], s[98:99] op_sel_hi:[1,0]
    v_cvt_pk_bf16_f32 v40, 0, v40
    v_cvt_pk_bf16_f32 v41, 0, v41
    v_cvt_pk_bf16_f32 v42, 0, v42
    v_cvt_pk_bf16_f32 v43, 0, v43
    v_cvt_pk_bf16_f32 v44, 0, v44
    v_cvt_pk_bf16_f32 v45, 0, v45
    v_cvt_pk_bf16_f32 v46, 0, v46
    v_cvt_pk_bf16_f32 v47, 0, v47
    v_cvt_pk_bf16_f32 v48, 0, v48
    v_cvt_pk_bf16_f32 v49, 0, v49
    v_pk_mul_f32 v[40:41], v[40:41], v[150:151]
    v_pk_mul_f32 v[42:43], v[42:43], v[152:153]
    v_pk_mul_f32 v[44:45], v[44:45], v[154:155]
    v_pk_mul_f32 v[46:47], v[46:47], v[156:157]
    v_pk_mul_f32 v[48:49], v[48:49], v[158:159]
    v_cvt_pk_bf16_f32 v40, 0, v40
    v_cvt_pk_bf16_f32 v41, 0, v41
    v_cvt_pk_bf16_f32 v42, 0, v42
    v_cvt_pk_bf16_f32 v43, 0, v43
    v_cvt_pk_bf16_f32 v44, 0, v44
    v_cvt_pk_bf16_f32 v45, 0, v45
    v_cvt_pk_bf16_f32 v46, 0, v46
    v_cvt_pk_bf16_f32 v47, 0, v47
    v_cvt_pk_bf16_f32 v48, 0, v48
    v_cvt_pk_bf16_f32 v49, 0, v49
    v_pk_add_f32 v[40:41], v[40:41], v[140:141]
    v_pk_add_f32 v[42:43], v[42:43], v[142:143]
    v_pk_add_f32 v[44:45], v[44:45], v[144:145]
    v_pk_add_f32 v[46:47], v[46:47], v[146:147]
    v_pk_add_f32 v[48:49], v[48:49], v[148:149]
    v_cvt_pk_bf16_f32 v26, v40, v41
    v_cvt_pk_bf16_f32 v27, v42, v43
    v_cvt_pk_bf16_f32 v28, v44, v45
    v_cvt_pk_bf16_f32 v29, v46, v47
    v_cvt_pk_bf16_f32 v30, v48, v49
    v_min_u32 v26, -2, v26
    v_min_u32 v27, -2, v27
    v_min_u32 v28, -2, v28
    v_min_u32 v29, -2, v29
    v_min_u32 v30, -2, v30
    buffer_store_dwordx2 v[26:27], v8, s[44:47], s92 offen sc1
    buffer_store_dwordx2 v[28:29], v8, s[44:47], s92 offen offset:512 sc1
    buffer_store_dword v30, v12, s[44:47], s92 offen offset:1024 sc1
    v_min_u32 v160, -2, v160
    v_min_u32 v161, -2, v161
    v_min_u32 v162, -2, v162
    v_min_u32 v163, -2, v163
    v_min_u32 v164, -2, v164
    buffer_store_dwordx2 v[160:161], v8, s[44:47], s93 offen sc1
    buffer_store_dwordx2 v[162:163], v8, s[44:47], s93 offen offset:512 sc1
    buffer_store_dword v164, v12, s[44:47], s93 offen offset:1024 sc1
L_ctrl_end:
    s_cmp_eq_u32 s7, 2
    s_cbranch_scc1 L_ctrl_fin
    s_cmp_eq_u32 s7, 3
    s_cbranch_scc1 L_ctrl_fin
    s_cmp_eq_u32 s7, 6
    s_cbranch_scc1 L_ctrl_fin
L_share:
    s_cmp_eq_u32 s7, 2
    s_cbranch_scc1 L_role_down
    s_cmp_eq_u32 s7, 3
    s_cbranch_scc1 L_role_ffn
    s_cmp_eq_u32 s7, 6
    s_cbranch_scc1 L_role_red
L_ctrl_fin:
    s_endpgm
L_code_end:
.section .rodata,"a"
.p2align 6
.amdhsa_kernel adaLN_cond__sliding_block_cached__glu_gated_reglu__decode_kernel
  .amdhsa_next_free_vgpr 168
  .amdhsa_next_free_sgpr 102
  .amdhsa_accum_offset 168
  .amdhsa_group_segment_fixed_size 0
  .amdhsa_kernarg_size 112
  .amdhsa_user_sgpr_count 2
  .amdhsa_user_sgpr_kernarg_segment_ptr 1
  .amdhsa_system_sgpr_workgroup_id_x 1
  .amdhsa_float_denorm_mode_32 3
  .amdhsa_float_denorm_mode_16_64 3
.end_amdhsa_kernel
```
